```python
import torch

def _softmax(x, axis=-1):
    return torch.softmax(x, dim=axis)
def _gelu(x):
    return torch.nn.functional.gelu(x, approximate="tanh")
def _silu(x):
    return torch.nn.functional.silu(x)
def _sigmoid(x):
    return torch.sigmoid(x)
def _layernorm(x, axis=-1, eps=1e-5):
    m = x.mean(dim=axis, keepdim=True)
    v = x.var(dim=axis, keepdim=True, unbiased=False)
    return (x - m) / torch.sqrt(v + eps)
def _scatter_add(tgt, idx, src, axis=0):
    return tgt.clone().index_add_(axis, idx, src)
def _segment_sum(src, seg, n):
    out = torch.zeros((n,) + src.shape[1:], dtype=src.dtype)
    return out.index_add_(0, seg, src)
def _pad(x, pw):
    flat = tuple(v for pair in reversed(pw) for v in pair)
    return torch.nn.functional.pad(x, flat)

kernel_name = 'standalone__glu_gated_bilinear__prompt'

def setup_inputs():

    _w = (lambda a: (lambda t: t.to(torch.bfloat16) if t.is_floating_point() else t)(torch.as_tensor(a)))
    B, S, D, F = 1, 2048, 640, 1728
    return {
        "x": _w((lambda *s: torch.randn(*s, dtype=torch.bfloat16) * 0.05)(B, S, D)),
        "w_gate": _w((lambda *s: torch.randn(*s, dtype=torch.bfloat16) * 0.05)(D, F) * (D ** -0.5)),
        "w_up": _w((lambda *s: torch.randn(*s, dtype=torch.bfloat16) * 0.05)(D, F) * (D ** -0.5)),
        "w_down": _w((lambda *s: torch.randn(*s, dtype=torch.bfloat16) * 0.05)(F, D) * (F ** -0.5)),
    }

def reference(x, w_gate, w_up, w_down):
    g = torch.einsum("bsd,df->bsf", x, w_gate)
    u = torch.einsum("bsd,df->bsf", x, w_up)
    h = g * u
    return torch.einsum("bsf,fd->bsd", h, w_down)
```

```asm
; @launch grid=(256,1,1) block=(256,1,1) lds=163840
.amdgcn_target "amdgcn-amd-amdhsa--gfx950"
.text
.p2align 12
.fill 0x340, 4, 0xbf800000
.globl standalone__glu_gated_bilinear__prompt_kernel
.p2align 8
.type standalone__glu_gated_bilinear__prompt_kernel,@function
standalone__glu_gated_bilinear__prompt_kernel:
    s_load_dwordx8 s[4:11], s[0:1], 0
    s_load_dwordx4 s[12:15], s[0:1], 32
    s_load_dwordx2 s[16:17], s[0:1], 48
    s_cmp_ge_u32 s2, 256
    s_cbranch_scc1 L_end
    v_lshrrev_b32 v2, 6, v0
    v_and_b32 v1, 63, v0
    v_readfirstlane_b32 s56, v2
    v_and_b32 v5, 7, v0
    s_getpc_b64 s[60:61]
L_pc:
    s_and_b32 s62, s2, 0xf8
    v_add_lshl_u32 v3, s62, v5, 7
    v_min_u32 v3, L_end-L_pc, v3
    s_mov_b64 exec, 0xff
    global_load_dword v3, v3, s[60:61]
    s_mov_b64 exec, -1
    s_lshr_b32 s19, s2, 5
    s_bfe_u32 s66, s2, 0x20001
    s_mul_i32 s57, s66, 7
    s_add_u32 s57, s57, s19
    s_cmp_ge_u32 s19, 7
    s_cbranch_scc1 L_spare
    s_cmp_ge_u32 s57, 27
    s_cbranch_scc1 L_spare
    s_bfe_u32 s58, s2, 0x20003
    s_add_u32 s3, s58, s19
    s_and_b32 s3, s3, 3
    s_and_b32 s64, s2, 1
    s_lshl2_add_u32 s58, s64, s58
    v_lshrrev_b32 v4, 3, v1
    v_lshrrev_b32 v6, 4, v1
    v_and_b32 v12, 1, v6
    v_lshlrev_b32 v12, 1, v12
    v_xor_b32 v12, v5, v12
    v_mul_u32_u24 v14, 3456, v4
    v_lshl_add_u32 v194, v12, 4, v14
    v_xor_b32 v13, 64, v194
    v_add_u32 v195, 26624, v13
    v_add_u32 v196, 53248, v194
    v_add_u32 v197, 79872, v13
    v_xor_b32 v7, v5, v6
    v_mul_u32_u24 v9, 1280, v4
    v_lshl_add_u32 v188, v7, 4, v9
    v_xor_b32 v11, 64, v188
    v_add_u32 v189, 9216, v11
    v_add_u32 v190, 18432, v188
    v_add_u32 v191, 30720, v11
    v_add_u32 v192, 39936, v188
    v_add_u32 v193, 49152, v11
    s_and_b32 s60, s56, 1
    s_mul_i32 s60, s60, 110592
    s_lshl_b32 s61, s57, 7
    s_add_u32 s60, s60, s61
    s_mul_i32 s61, s56, 3
    s_lshl4_add_u32 s61, s58, s61
    s_mul_i32 s61, s61, 20480
    s_lshl_b32 s62, s3, 3
    s_lshr_b32 s62, 1, s62
    s_and_b32 s62, s62, 15
    s_and_b32 s63, s2, 7
    s_lshl_b32 s63, s63, 2
    s_lshr_b32 s63, 89130320, s63
    s_and_b32 s59, s63, 15
    s_add_u32 s62, s62, s59
    s_sub_u32 s63, s62, 10
    s_min_u32 s62, s62, s63
    s_lshl_b32 s44, s62, 7
    s_lshl_b32 s73, s56, 12
    s_mul_i32 s72, s56, 6144
    s_sub_u32 s26, 2211840, s60
    s_mov_b32 s27, 0x00020000
    s_sub_u32 s22, 2621440, s61
    s_mov_b32 s23, 0x00020000
    s_cmp_lt_u32 s56, 2
    s_waitcnt lgkmcnt(0)
    s_cselect_b32 s24, s6, s8
    s_cselect_b32 s25, s7, s9
    s_add_u32 s24, s24, s60
    s_addc_u32 s25, s25, 0
    s_add_u32 s20, s4, s61
    s_addc_u32 s21, s5, 0
    s_mul_i32 s71, s44, 1728
    s_add_u32 m0, s73, 24576
    s_nop 0
    buffer_load_dwordx4 v194, s[24:27], s71 offen lds
    buffer_load_dwordx4 v195, s[24:27], s71 offen offset:1024 lds
    buffer_load_dwordx4 v196, s[24:27], s71 offen offset:2048 lds
    buffer_load_dwordx4 v197, s[24:27], s71 offen offset:3072 lds
    s_add_u32 m0, s72, 0
    s_nop 0
    buffer_load_dwordx4 v188, s[20:23], s44 offen lds
    buffer_load_dwordx4 v189, s[20:23], s44 offen offset:1024 lds
    buffer_load_dwordx4 v190, s[20:23], s44 offen offset:2048 lds
    s_add_u32 m0, s72, 3072
    s_nop 0
    buffer_load_dwordx4 v191, s[20:23], s44 offen lds
    buffer_load_dwordx4 v192, s[20:23], s44 offen offset:1024 lds
    buffer_load_dwordx4 v193, s[20:23], s44 offen offset:2048 lds
    v_and_b32 v5, 15, v1
    v_lshrrev_b32 v7, 1, v5
    v_xor_b32 v7, v6, v7
    v_lshlrev_b32 v7, 4, v7
    v_lshl_add_u32 v198, v5, 7, v7
    v_xor_b32 v199, 64, v198
    v_add_u32 v200, 81920, v198
    v_add_u32 v201, 81920, v199
    v_lshrrev_b32 v7, 2, v5
    v_lshl_add_u32 v8, v6, 3, v7
    v_lshrrev_b32 v9, 1, v7
    v_and_b32 v10, 1, v6
    v_lshl_add_u32 v9, v10, 1, v9
    v_xor_b32 v9, s56, v9
    v_lshlrev_b32 v9, 5, v9
    v_lshl_add_u32 v8, v8, 7, v9
    v_and_b32 v9, 3, v1
    v_lshl_add_u32 v8, v9, 3, v8
    v_add_u32 v202, 24576, v8
    v_add_u32 v203, 106496, v8
    s_lshl2_add_u32 s67, s58, s66
    s_lshl3_add_u32 s67, s67, s19
    s_lshl_b32 s67, s67, 8
    s_mul_i32 s18, s58, 1728
    s_lshl2_add_u32 s60, s57, s56
    s_add_u32 s18, s18, s60
    s_lshl_b32 s18, s18, 9
    s_mov_b32 s68, 340481
    s_cmp_eq_u32 s3, 1
    s_cselect_b32 s68, 274720, s68
    s_cmp_eq_u32 s3, 2
    s_cselect_b32 s68, 271120, s68
    s_cmp_eq_u32 s3, 3
    s_cselect_b32 s68, 213520, s68
    s_mov_b32 s69, 563044
    s_cmp_eq_u32 s3, 1
    s_cselect_b32 s69, 624470, s69
    s_cmp_eq_u32 s3, 2
    s_cselect_b32 s69, 624245, s69
    s_cmp_eq_u32 s3, 3
    s_cselect_b32 s69, 620645, s69
    s_bfe_u32 s45, s68, 262148
    s_add_u32 s45, s45, s59
    s_sub_u32 s60, s45, 10
    s_min_u32 s45, s45, s60
    s_lshl_b32 s45, s45, 7
    s_bfe_u32 s48, s68, 262152
    s_add_u32 s48, s48, s59
    s_sub_u32 s60, s48, 10
    s_min_u32 s48, s48, s60
    s_lshl_b32 s48, s48, 7
    s_bfe_u32 s49, s68, 262156
    s_add_u32 s49, s49, s59
    s_sub_u32 s60, s49, 10
    s_min_u32 s49, s49, s60
    s_lshl_b32 s49, s49, 7
    s_bfe_u32 s50, s68, 262160
    s_add_u32 s50, s50, s59
    s_sub_u32 s60, s50, 10
    s_min_u32 s50, s50, s60
    s_lshl_b32 s50, s50, 7
    s_bfe_u32 s51, s69, 262144
    s_add_u32 s51, s51, s59
    s_sub_u32 s60, s51, 10
    s_min_u32 s51, s51, s60
    s_lshl_b32 s51, s51, 7
    s_bfe_u32 s78, s69, 262148
    s_add_u32 s78, s78, s59
    s_sub_u32 s60, s78, 10
    s_min_u32 s78, s78, s60
    s_lshl_b32 s78, s78, 7
    s_bfe_u32 s79, s69, 262152
    s_add_u32 s79, s79, s59
    s_sub_u32 s60, s79, 10
    s_min_u32 s79, s79, s60
    s_lshl_b32 s79, s79, 7
    s_bfe_u32 s57, s69, 262156
    s_add_u32 s57, s57, s59
    s_sub_u32 s60, s57, 10
    s_min_u32 s57, s57, s60
    s_lshl_b32 s57, s57, 7
    s_bfe_u32 s58, s69, 262160
    s_add_u32 s58, s58, s59
    s_sub_u32 s60, s58, 10
    s_min_u32 s58, s58, s60
    s_lshl_b32 s58, s58, 7
    s_bitcmp1_b32 s56, 0
    s_cselect_b32 s74, s69, s68
    s_add_u32 s28, s16, 0
    s_addc_u32 s29, s17, 0
    s_mov_b32 s30, 7077888
    s_mov_b32 s31, 0x00020000
    s_add_u32 s32, s16, 8519680
    s_addc_u32 s33, s17, 0
    s_mov_b32 s34, 2211840
    s_mov_b32 s35, 0x00020000
    s_mov_b64 s[46:47], s[14:15]
    s_add_u32 s42, s16, 8388608
    s_addc_u32 s43, s17, 0
    s_add_u32 s40, s42, s67
    s_addc_u32 s41, s43, 0
    s_mov_b64 s[36:37], s[12:13]
    s_mov_b32 s38, 2621440
    s_mov_b32 s39, 0x00020000
    s_lshr_b32 s60, s2, 5
    s_bfe_u32 s76, s2, 0x20001
    s_lshl3_add_u32 s76, s76, s60
    s_and_b32 s60, s76, 0xfc
    s_add_u32 s60, s60, s56
    s_lshl_b32 s60, s60, 11
    s_add_u32 s42, s42, s60
    s_addc_u32 s43, s43, 0
    s_mov_b64 exec, 0
    s_cmp_eq_u32 s56, 0
    s_cbranch_scc1 L_pad0
    s_cmp_eq_u32 s56, 1
    s_cbranch_scc1 L_pad1
    s_cmp_eq_u32 s56, 2
    s_cbranch_scc1 L_pad2
    s_branch L_pad3
L_padret:
    s_mov_b64 exec, -1
    s_mul_i32 s71, s45, 1728
    s_add_u32 m0, s73, 65536
    s_nop 0
    buffer_load_dwordx4 v194, s[24:27], s71 offen lds
    buffer_load_dwordx4 v195, s[24:27], s71 offen offset:1024 lds
    buffer_load_dwordx4 v196, s[24:27], s71 offen offset:2048 lds
    buffer_load_dwordx4 v197, s[24:27], s71 offen offset:3072 lds
    s_add_u32 m0, s72, 40960
    s_nop 0
    buffer_load_dwordx4 v188, s[20:23], s45 offen lds
    buffer_load_dwordx4 v189, s[20:23], s45 offen offset:1024 lds
    buffer_load_dwordx4 v190, s[20:23], s45 offen offset:2048 lds
    s_add_u32 m0, s72, 44032
    s_nop 0
    buffer_load_dwordx4 v191, s[20:23], s45 offen lds
    buffer_load_dwordx4 v192, s[20:23], s45 offen offset:1024 lds
    buffer_load_dwordx4 v193, s[20:23], s45 offen offset:2048 lds
    s_waitcnt vmcnt(10)
    s_barrier
    ds_read_b64_tr_b16 a[0:1], v202 offset:0
    ds_read_b64_tr_b16 a[2:3], v202 offset:512
    ds_read_b128 v[128:131], v198 offset:0
    ds_read_b64_tr_b16 a[4:5], v202 offset:8192
    ds_read_b64_tr_b16 a[6:7], v202 offset:8704
    ds_read_b128 v[132:135], v198 offset:2048
    ds_read_b128 v[136:139], v198 offset:4096
    ds_read_b128 v[140:143], v198 offset:6144
    ds_read_b128 v[144:147], v198 offset:8192
    ds_read_b128 v[148:151], v198 offset:10240
    ds_read_b128 v[152:155], v198 offset:12288
    ds_read_b128 v[156:159], v198 offset:14336
    ds_read_b128 v[160:163], v198 offset:16384
    ds_read_b128 v[164:167], v198 offset:18432
    ds_read_b128 v[168:171], v198 offset:20480
    ds_read_b128 v[172:175], v198 offset:22528
    s_waitcnt lgkmcnt(13)
    v_mfma_f32_16x16x32_bf16 v[16:19], a[0:3], v[128:131], 0
    ds_read_b128 v[176:179], v199 offset:0
    s_waitcnt lgkmcnt(12)
    v_mfma_f32_16x16x32_bf16 v[20:23], a[4:7], v[128:131], 0
    ds_read_b128 v[180:183], v199 offset:2048
    s_waitcnt lgkmcnt(12)
    v_mfma_f32_16x16x32_bf16 v[24:27], a[0:3], v[132:135], 0
    ds_read_b128 v[184:187], v199 offset:4096
    v_mfma_f32_16x16x32_bf16 v[28:31], a[4:7], v[132:135], 0
    ds_read_b128 v[128:131], v199 offset:6144
    s_waitcnt lgkmcnt(13)
    v_mfma_f32_16x16x32_bf16 v[32:35], a[0:3], v[136:139], 0
    ds_read_b128 v[132:135], v199 offset:8192
    v_mul_u32_u24 v7, 55296, v10
    v_mfma_f32_16x16x32_bf16 v[36:39], a[4:7], v[136:139], 0
    ds_read_b128 v[136:139], v199 offset:10240
    v_lshrrev_b32 v6, 1, v6
    s_waitcnt lgkmcnt(14)
    v_mfma_f32_16x16x32_bf16 v[40:43], a[0:3], v[140:143], 0
    ds_read_b64_tr_b16 a[8:9], v202 offset:4096
    ds_read_b64_tr_b16 a[10:11], v202 offset:4608
    v_mfma_f32_16x16x32_bf16 v[44:47], a[4:7], v[140:143], 0
    ds_read_b128 v[140:143], v199 offset:12288
    v_lshlrev_b32 v6, 8, v6
    s_waitcnt lgkmcnt(3)
    v_mfma_f32_16x16x32_bf16 v[48:51], a[0:3], v[144:147], 0
    ds_read_b64_tr_b16 a[12:13], v202 offset:12288
    ds_read_b64_tr_b16 a[14:15], v202 offset:12800
    v_mfma_f32_16x16x32_bf16 v[52:55], a[4:7], v[144:147], 0
    ds_read_b128 v[144:147], v199 offset:14336
    v_lshl_add_u32 v6, v5, 4, v6
    v_mfma_f32_16x16x32_bf16 v[56:59], a[0:3], v[148:151], 0
    s_mul_i32 s71, s48, 1728
    s_add_u32 m0, s73, 106496
    v_mfma_f32_16x16x32_bf16 v[60:63], a[4:7], v[148:151], 0
    ds_read_b128 v[148:151], v199 offset:16384
    v_add3_u32 v204, v7, v6, s18
    v_mfma_f32_16x16x32_bf16 v[64:67], a[0:3], v[152:155], 0
    buffer_load_dwordx4 v194, s[24:27], s71 offen lds
    v_mfma_f32_16x16x32_bf16 v[68:71], a[4:7], v[152:155], 0
    ds_read_b128 v[152:155], v199 offset:18432
    s_mov_b32 s75, 0
    v_mfma_f32_16x16x32_bf16 v[72:75], a[0:3], v[156:159], 0
    buffer_load_dwordx4 v195, s[24:27], s71 offen offset:1024 lds
    v_mfma_f32_16x16x32_bf16 v[76:79], a[4:7], v[156:159], 0
    ds_read_b128 v[156:159], v199 offset:20480
    s_lshr_b32 s62, s2, 5
    v_mfma_f32_16x16x32_bf16 v[80:83], a[0:3], v[160:163], 0
    buffer_load_dwordx4 v196, s[24:27], s71 offen offset:2048 lds
    v_mfma_f32_16x16x32_bf16 v[84:87], a[4:7], v[160:163], 0
    ds_read_b128 v[160:163], v199 offset:22528
    s_bfe_u32 s63, s2, 0x20003
    v_mfma_f32_16x16x32_bf16 v[88:91], a[0:3], v[164:167], 0
    buffer_load_dwordx4 v197, s[24:27], s71 offen offset:3072 lds
    v_mfma_f32_16x16x32_bf16 v[92:95], a[4:7], v[164:167], 0
    s_add_u32 m0, s72, 81920
    s_and_b32 s77, s2, 1
    v_mfma_f32_16x16x32_bf16 v[96:99], a[0:3], v[168:171], 0
    buffer_load_dwordx4 v188, s[20:23], s48 offen lds
    v_mfma_f32_16x16x32_bf16 v[100:103], a[4:7], v[168:171], 0
    s_lshl2_add_u32 s77, s77, s63
    s_mul_i32 s60, s77, 270
    v_mfma_f32_16x16x32_bf16 v[104:107], a[0:3], v[172:175], 0
    buffer_load_dwordx4 v189, s[20:23], s48 offen offset:1024 lds
    v_mfma_f32_16x16x32_bf16 v[108:111], a[4:7], v[172:175], 0
    s_waitcnt vmcnt(6) lgkmcnt(0)
    s_barrier
    v_mfma_f32_16x16x32_bf16 v[16:19], a[8:11], v[176:179], v[16:19]
    ds_read_b128 v[164:167], v198 offset:40960
    s_mul_i32 s61, s56, 14
    v_mfma_f32_16x16x32_bf16 v[20:23], a[12:15], v[176:179], v[20:23]
    ds_read_b128 v[168:171], v198 offset:43008
    s_add_u32 s60, s60, s61
    v_mfma_f32_16x16x32_bf16 v[24:27], a[8:11], v[180:183], v[24:27]
    ds_read_b128 v[172:175], v198 offset:45056
    s_lshl_b32 s60, s60, 10
    v_mfma_f32_16x16x32_bf16 v[28:31], a[12:15], v[180:183], v[28:31]
    ds_read_b128 v[176:179], v198 offset:47104
    v_lshl_add_u32 v8, v1, 4, s60
    v_mfma_f32_16x16x32_bf16 v[32:35], a[8:11], v[184:187], v[32:35]
    ds_read_b128 v[180:183], v198 offset:49152
    v_add_u32 v9, 55296, v8
    v_mfma_f32_16x16x32_bf16 v[36:39], a[12:15], v[184:187], v[36:39]
    ds_read_b128 v[184:187], v198 offset:51200
    v_add_u32 v10, 110592, v8
    v_mfma_f32_16x16x32_bf16 v[40:43], a[8:11], v[128:131], v[40:43]
    ds_read_b64_tr_b16 a[16:17], v202 offset:40960
    ds_read_b64_tr_b16 a[18:19], v202 offset:41472
    v_mfma_f32_16x16x32_bf16 v[44:47], a[12:15], v[128:131], v[44:47]
    ds_read_b128 v[128:131], v198 offset:53248
    v_add_u32 v11, 165888, v8
    v_mfma_f32_16x16x32_bf16 v[48:51], a[8:11], v[132:135], v[48:51]
    ds_read_b64_tr_b16 a[20:21], v202 offset:49152
    ds_read_b64_tr_b16 a[22:23], v202 offset:49664
    v_mfma_f32_16x16x32_bf16 v[52:55], a[12:15], v[132:135], v[52:55]
    ds_read_b128 v[132:135], v198 offset:55296
    v_add_u32 v12, 221184, v8
    v_mfma_f32_16x16x32_bf16 v[56:59], a[8:11], v[136:139], v[56:59]
    buffer_load_dwordx4 v190, s[20:23], s48 offen offset:2048 lds
    v_mfma_f32_16x16x32_bf16 v[60:63], a[12:15], v[136:139], v[60:63]
    ds_read_b128 v[136:139], v198 offset:57344
    s_add_u32 m0, s72, 84992
    v_mfma_f32_16x16x32_bf16 v[64:67], a[8:11], v[140:143], v[64:67]
    buffer_load_dwordx4 v191, s[20:23], s48 offen lds
    v_mfma_f32_16x16x32_bf16 v[68:71], a[12:15], v[140:143], v[68:71]
    ds_read_b128 v[140:143], v198 offset:59392
    s_add_u32 s60, s56, 1
    v_mfma_f32_16x16x32_bf16 v[72:75], a[8:11], v[144:147], v[72:75]
    buffer_load_dwordx4 v192, s[20:23], s48 offen offset:1024 lds
    v_mfma_f32_16x16x32_bf16 v[76:79], a[12:15], v[144:147], v[76:79]
    ds_read_b128 v[144:147], v198 offset:61440
    s_lshr_b32 s60, s60, 2
    v_mfma_f32_16x16x32_bf16 v[80:83], a[8:11], v[148:151], v[80:83]
    buffer_load_dwordx4 v193, s[20:23], s48 offen offset:2048 lds
    v_mfma_f32_16x16x32_bf16 v[84:87], a[12:15], v[148:151], v[84:87]
    ds_read_b128 v[148:151], v198 offset:63488
    s_sub_u32 s60, 6, s60
    v_mfma_f32_16x16x32_bf16 v[88:91], a[8:11], v[152:155], v[88:91]
    s_mul_i32 s71, s49, 1728
    s_add_u32 m0, s73, 147456
    v_mfma_f32_16x16x32_bf16 v[92:95], a[12:15], v[152:155], v[92:95]
    ds_read_b128 v[152:155], v199 offset:40960
    s_lshl1_add_u32 s64, s60, 1
    v_mfma_f32_16x16x32_bf16 v[96:99], a[8:11], v[156:159], v[96:99]
    buffer_load_dwordx4 v194, s[24:27], s71 offen lds
    v_mfma_f32_16x16x32_bf16 v[100:103], a[12:15], v[156:159], v[100:103]
    ds_read_b128 v[156:159], v199 offset:43008
    v_min_u32 v13, s60, v1
    v_mfma_f32_16x16x32_bf16 v[104:107], a[8:11], v[160:163], v[104:107]
    buffer_load_dwordx4 v195, s[24:27], s71 offen offset:1024 lds
    v_mfma_f32_16x16x32_bf16 v[108:111], a[12:15], v[160:163], v[108:111]
    ds_read_b128 v[160:163], v199 offset:45056
    v_lshlrev_b32 v13, 8, v13
    s_waitcnt lgkmcnt(3)
    v_mfma_f32_16x16x32_bf16 v[16:19], a[16:19], v[164:167], v[16:19]
    ds_read_b64_tr_b16 a[24:25], v202 offset:45056
    ds_read_b64_tr_b16 a[26:27], v202 offset:45568
    v_mfma_f32_16x16x32_bf16 v[20:23], a[20:23], v[164:167], v[20:23]
    ds_read_b128 v[164:167], v199 offset:47104
    s_mul_i32 s62, s62, 0
    v_mfma_f32_16x16x32_bf16 v[24:27], a[16:19], v[168:171], v[24:27]
    ds_read_b64_tr_b16 a[28:29], v202 offset:53248
    ds_read_b64_tr_b16 a[30:31], v202 offset:53760
    v_mfma_f32_16x16x32_bf16 v[28:31], a[20:23], v[168:171], v[28:31]
    ds_read_b128 v[168:171], v199 offset:49152
    s_mul_i32 s63, s63, 14
    v_mfma_f32_16x16x32_bf16 v[32:35], a[16:19], v[172:175], v[32:35]
    buffer_load_dwordx4 v196, s[24:27], s71 offen offset:2048 lds
    v_mfma_f32_16x16x32_bf16 v[36:39], a[20:23], v[172:175], v[36:39]
    ds_read_b128 v[172:175], v199 offset:51200
    s_add_u32 s62, s62, s63
    v_mfma_f32_16x16x32_bf16 v[40:43], a[16:19], v[176:179], v[40:43]
    buffer_load_dwordx4 v197, s[24:27], s71 offen offset:3072 lds
    v_mfma_f32_16x16x32_bf16 v[44:47], a[20:23], v[176:179], v[44:47]
    ds_read_b128 v[176:179], v199 offset:53248
    s_lshr_b32 s62, s62, 2
    v_mfma_f32_16x16x32_bf16 v[48:51], a[16:19], v[180:183], v[48:51]
    s_add_u32 m0, s72, 122880
    v_add_u32 v2, s62, v1
    v_mfma_f32_16x16x32_bf16 v[52:55], a[20:23], v[180:183], v[52:55]
    ds_read_b128 v[180:183], v199 offset:55296
    v_subrev_u32 v4, 14, v2
    v_mfma_f32_16x16x32_bf16 v[56:59], a[16:19], v[184:187], v[56:59]
    buffer_load_dwordx4 v188, s[20:23], s49 offen lds
    v_mfma_f32_16x16x32_bf16 v[60:63], a[20:23], v[184:187], v[60:63]
    ds_read_b128 v[184:187], v199 offset:57344
    v_min_u32 v2, v2, v4
    v_mfma_f32_16x16x32_bf16 v[64:67], a[16:19], v[128:131], v[64:67]
    v_subrev_u32 v4, 14, v2
    v_min_u32 v2, v2, v4
    v_mfma_f32_16x16x32_bf16 v[68:71], a[20:23], v[128:131], v[68:71]
    ds_read_b128 v[128:131], v199 offset:59392
    v_sub_u32 v4, s64, v2
    v_mfma_f32_16x16x32_bf16 v[72:75], a[16:19], v[132:135], v[72:75]
    buffer_load_dwordx4 v189, s[20:23], s49 offen offset:1024 lds
    v_mfma_f32_16x16x32_bf16 v[76:79], a[20:23], v[132:135], v[76:79]
    ds_read_b128 v[132:135], v199 offset:61440
    v_and_b32 v4, 2147483648, v4
    v_mfma_f32_16x16x32_bf16 v[80:83], a[16:19], v[136:139], v[80:83]
    v_lshl_or_b32 v2, v2, 10, v4
    s_nop 0
    v_mfma_f32_16x16x32_bf16 v[84:87], a[20:23], v[136:139], v[84:87]
    ds_read_b128 v[136:139], v199 offset:63488
    v_readlane_b32 s4, v2, 0
    v_mfma_f32_16x16x32_bf16 v[88:91], a[16:19], v[140:143], v[88:91]
    buffer_load_dwordx4 v190, s[20:23], s49 offen offset:2048 lds
    v_mfma_f32_16x16x32_bf16 v[92:95], a[20:23], v[140:143], v[92:95]
    v_readlane_b32 s5, v2, 1
    v_readlane_b32 s6, v2, 2
    v_mfma_f32_16x16x32_bf16 v[96:99], a[16:19], v[144:147], v[96:99]
    s_add_u32 m0, s72, 125952
    v_readlane_b32 s7, v2, 3
    v_mfma_f32_16x16x32_bf16 v[100:103], a[20:23], v[144:147], v[100:103]
    v_readlane_b32 s8, v2, 4
    v_readlane_b32 s9, v2, 5
    v_mfma_f32_16x16x32_bf16 v[104:107], a[16:19], v[148:151], v[104:107]
    buffer_load_dwordx4 v191, s[20:23], s49 offen lds
    v_mfma_f32_16x16x32_bf16 v[108:111], a[20:23], v[148:151], v[108:111]
    s_waitcnt vmcnt(8) lgkmcnt(0)
    s_barrier
    v_mfma_f32_16x16x32_bf16 v[16:19], a[24:27], v[152:155], v[16:19]
    ds_read_b128 v[140:143], v200 offset:0
    v_readlane_b32 s10, v2, 6
    v_mfma_f32_16x16x32_bf16 v[20:23], a[28:31], v[152:155], v[20:23]
    ds_read_b128 v[144:147], v200 offset:2048
    v_readlane_b32 s11, v2, 7
    v_mfma_f32_16x16x32_bf16 v[24:27], a[24:27], v[156:159], v[24:27]
    ds_read_b128 v[148:151], v200 offset:4096
    v_readlane_b32 s12, v2, 8
    v_mfma_f32_16x16x32_bf16 v[28:31], a[28:31], v[156:159], v[28:31]
    ds_read_b128 v[152:155], v200 offset:6144
    v_readlane_b32 s13, v2, 9
    v_mfma_f32_16x16x32_bf16 v[32:35], a[24:27], v[160:163], v[32:35]
    ds_read_b128 v[156:159], v200 offset:8192
    v_readlane_b32 s14, v2, 10
    v_mfma_f32_16x16x32_bf16 v[36:39], a[28:31], v[160:163], v[36:39]
    ds_read_b128 v[160:163], v200 offset:10240
    v_readlane_b32 s15, v2, 11
    v_mfma_f32_16x16x32_bf16 v[40:43], a[24:27], v[164:167], v[40:43]
    ds_read_b64_tr_b16 a[32:33], v203 offset:0
    ds_read_b64_tr_b16 a[34:35], v203 offset:512
    v_mfma_f32_16x16x32_bf16 v[44:47], a[28:31], v[164:167], v[44:47]
    ds_read_b128 v[164:167], v200 offset:12288
    v_readlane_b32 s16, v2, 12
    v_mfma_f32_16x16x32_bf16 v[48:51], a[24:27], v[168:171], v[48:51]
    ds_read_b64_tr_b16 a[36:37], v203 offset:8192
    ds_read_b64_tr_b16 a[38:39], v203 offset:8704
    v_mfma_f32_16x16x32_bf16 v[52:55], a[28:31], v[168:171], v[52:55]
    ds_read_b128 v[168:171], v200 offset:14336
    v_readlane_b32 s17, v2, 13
    v_mfma_f32_16x16x32_bf16 v[56:59], a[24:27], v[172:175], v[56:59]
    buffer_load_dwordx4 v192, s[20:23], s49 offen offset:1024 lds
    v_mfma_f32_16x16x32_bf16 v[60:63], a[28:31], v[172:175], v[60:63]
    ds_read_b128 v[172:175], v200 offset:16384
    s_lshr_b32 s0, s56, 1
    v_mfma_f32_16x16x32_bf16 v[64:67], a[24:27], v[176:179], v[64:67]
    buffer_load_dwordx4 v193, s[20:23], s49 offen offset:2048 lds
    v_mfma_f32_16x16x32_bf16 v[68:71], a[28:31], v[176:179], v[68:71]
    ds_read_b128 v[176:179], v200 offset:18432
    s_mul_i32 s1, s56, 3
    v_mfma_f32_16x16x32_bf16 v[72:75], a[24:27], v[180:183], v[72:75]
    s_mul_i32 s71, s50, 1728
    s_add_u32 m0, s73, 24576
    v_mfma_f32_16x16x32_bf16 v[76:79], a[28:31], v[180:183], v[76:79]
    ds_read_b128 v[180:183], v200 offset:20480
    s_sub_u32 s0, s0, s1
    v_mfma_f32_16x16x32_bf16 v[80:83], a[24:27], v[184:187], v[80:83]
    buffer_load_dwordx4 v194, s[24:27], s71 offen lds
    v_mfma_f32_16x16x32_bf16 v[84:87], a[28:31], v[184:187], v[84:87]
    ds_read_b128 v[184:187], v200 offset:22528
    s_add_u32 s0, s0, 12
    v_mfma_f32_16x16x32_bf16 v[88:91], a[24:27], v[128:131], v[88:91]
    buffer_load_dwordx4 v195, s[24:27], s71 offen offset:1024 lds
    v_mfma_f32_16x16x32_bf16 v[92:95], a[28:31], v[128:131], v[92:95]
    ds_read_b128 v[128:131], v201 offset:0
    s_mul_i32 s0, s0, 20480
    v_mfma_f32_16x16x32_bf16 v[96:99], a[24:27], v[132:135], v[96:99]
    buffer_load_dwordx4 v196, s[24:27], s71 offen offset:2048 lds
    v_mfma_f32_16x16x32_bf16 v[100:103], a[28:31], v[132:135], v[100:103]
    ds_read_b128 v[132:135], v201 offset:2048
    s_sub_u32 s1, s0, 2048
    v_mfma_f32_16x16x32_bf16 v[104:107], a[24:27], v[136:139], v[104:107]
    buffer_load_dwordx4 v197, s[24:27], s71 offen offset:3072 lds
    v_mfma_f32_16x16x32_bf16 v[108:111], a[28:31], v[136:139], v[108:111]
    ds_read_b128 v[136:139], v201 offset:4096
    s_bfe_u32 s60, s74, 262144
    s_waitcnt lgkmcnt(3)
    v_mfma_f32_16x16x32_bf16 v[16:19], a[32:35], v[140:143], v[16:19]
    ds_read_b64_tr_b16 a[40:41], v203 offset:4096
    ds_read_b64_tr_b16 a[42:43], v203 offset:4608
    v_mfma_f32_16x16x32_bf16 v[20:23], a[36:39], v[140:143], v[20:23]
    ds_read_b128 v[140:143], v201 offset:6144
    s_add_u32 m0, s72, 0
    v_mfma_f32_16x16x32_bf16 v[24:27], a[32:35], v[144:147], v[24:27]
    ds_read_b64_tr_b16 a[44:45], v203 offset:12288
    ds_read_b64_tr_b16 a[46:47], v203 offset:12800
    v_mfma_f32_16x16x32_bf16 v[28:31], a[36:39], v[144:147], v[28:31]
    ds_read_b128 v[144:147], v201 offset:8192
    s_add_u32 s60, s60, s59
    v_mfma_f32_16x16x32_bf16 v[32:35], a[32:35], v[148:151], v[32:35]
    buffer_load_dwordx4 v188, s[20:23], s50 offen lds
    v_mfma_f32_16x16x32_bf16 v[36:39], a[36:39], v[148:151], v[36:39]
    ds_read_b128 v[148:151], v201 offset:10240
    s_sub_u32 s70, s60, 10
    v_mfma_f32_16x16x32_bf16 v[40:43], a[32:35], v[152:155], v[40:43]
    buffer_load_dwordx4 v189, s[20:23], s50 offen offset:1024 lds
    v_mfma_f32_16x16x32_bf16 v[44:47], a[36:39], v[152:155], v[44:47]
    ds_read_b128 v[152:155], v201 offset:12288
    s_min_u32 s60, s60, s70
    v_mfma_f32_16x16x32_bf16 v[48:51], a[32:35], v[156:159], v[48:51]
    s_lshl_b32 s60, s60, 7
    s_add_u32 s60, s60, s0
    v_mfma_f32_16x16x32_bf16 v[52:55], a[36:39], v[156:159], v[52:55]
    ds_read_b128 v[156:159], v201 offset:14336
    s_bfe_u32 s61, s74, 262148
    v_mfma_f32_16x16x32_bf16 v[56:59], a[32:35], v[160:163], v[56:59]
    buffer_load_dwordx4 v190, s[20:23], s50 offen offset:2048 lds
    v_mfma_f32_16x16x32_bf16 v[60:63], a[36:39], v[160:163], v[60:63]
    ds_read_b128 v[160:163], v201 offset:16384
    s_add_u32 s61, s61, s59
    v_mfma_f32_16x16x32_bf16 v[64:67], a[32:35], v[164:167], v[64:67]
    s_add_u32 m0, s72, 3072
    s_sub_u32 s70, s61, 10
    v_mfma_f32_16x16x32_bf16 v[68:71], a[36:39], v[164:167], v[68:71]
    ds_read_b128 v[164:167], v201 offset:18432
    s_min_u32 s61, s61, s70
    v_mfma_f32_16x16x32_bf16 v[72:75], a[32:35], v[168:171], v[72:75]
    buffer_load_dwordx4 v191, s[20:23], s50 offen lds
    v_mfma_f32_16x16x32_bf16 v[76:79], a[36:39], v[168:171], v[76:79]
    ds_read_b128 v[168:171], v201 offset:20480
    s_lshl_b32 s61, s61, 7
    v_mfma_f32_16x16x32_bf16 v[80:83], a[32:35], v[172:175], v[80:83]
    s_add_u32 s61, s61, s1
    s_bfe_u32 s62, s74, 262152
    v_mfma_f32_16x16x32_bf16 v[84:87], a[36:39], v[172:175], v[84:87]
    ds_read_b128 v[172:175], v201 offset:22528
    s_add_u32 s62, s62, s59
    v_mfma_f32_16x16x32_bf16 v[88:91], a[32:35], v[176:179], v[88:91]
    buffer_load_dwordx4 v192, s[20:23], s50 offen offset:1024 lds
    v_mfma_f32_16x16x32_bf16 v[92:95], a[36:39], v[176:179], v[92:95]
    s_sub_u32 s70, s62, 10
    s_min_u32 s62, s62, s70
    v_mfma_f32_16x16x32_bf16 v[96:99], a[32:35], v[180:183], v[96:99]
    s_lshl_b32 s62, s62, 7
    s_add_u32 s62, s62, s0
    v_mfma_f32_16x16x32_bf16 v[100:103], a[36:39], v[180:183], v[100:103]
    s_bfe_u32 s63, s74, 262156
    s_add_u32 s63, s63, s59
    v_mfma_f32_16x16x32_bf16 v[104:107], a[32:35], v[184:187], v[104:107]
    buffer_load_dwordx4 v193, s[20:23], s50 offen offset:2048 lds
    v_mfma_f32_16x16x32_bf16 v[108:111], a[36:39], v[184:187], v[108:111]
    s_waitcnt vmcnt(10) lgkmcnt(0)
    s_barrier
    v_mfma_f32_16x16x32_bf16 v[16:19], a[40:43], v[128:131], v[16:19]
    ds_read_b128 v[176:179], v200 offset:40960
    s_sub_u32 s70, s63, 10
    v_mfma_f32_16x16x32_bf16 v[20:23], a[44:47], v[128:131], v[20:23]
    ds_read_b128 v[180:183], v200 offset:43008
    s_min_u32 s63, s63, s70
    v_mfma_f32_16x16x32_bf16 v[24:27], a[40:43], v[132:135], v[24:27]
    ds_read_b128 v[184:187], v200 offset:45056
    s_lshl_b32 s63, s63, 7
    v_mfma_f32_16x16x32_bf16 v[28:31], a[44:47], v[132:135], v[28:31]
    ds_read_b128 v[128:131], v200 offset:47104
    s_add_u32 s63, s63, s1
    v_mfma_f32_16x16x32_bf16 v[32:35], a[40:43], v[136:139], v[32:35]
    ds_read_b128 v[132:135], v200 offset:49152
    s_bfe_u32 s64, s74, 262160
    v_mfma_f32_16x16x32_bf16 v[36:39], a[44:47], v[136:139], v[36:39]
    ds_read_b128 v[136:139], v200 offset:51200
    s_add_u32 s64, s64, s59
    v_mfma_f32_16x16x32_bf16 v[40:43], a[40:43], v[140:143], v[40:43]
    ds_read_b64_tr_b16 a[48:49], v203 offset:40960
    ds_read_b64_tr_b16 a[50:51], v203 offset:41472
    v_mfma_f32_16x16x32_bf16 v[44:47], a[44:47], v[140:143], v[44:47]
    ds_read_b128 v[140:143], v200 offset:53248
    s_sub_u32 s70, s64, 10
    v_mfma_f32_16x16x32_bf16 v[48:51], a[40:43], v[144:147], v[48:51]
    ds_read_b64_tr_b16 a[52:53], v203 offset:49152
    ds_read_b64_tr_b16 a[54:55], v203 offset:49664
    v_mfma_f32_16x16x32_bf16 v[52:55], a[44:47], v[144:147], v[52:55]
    ds_read_b128 v[144:147], v200 offset:55296
    s_min_u32 s64, s64, s70
L_pad0:
    s_cbranch_execz L_padret
    v_mfma_f32_16x16x32_bf16 v[56:59], a[40:43], v[148:151], v[56:59]
    s_mul_i32 s71, s51, 1728
    s_add_u32 m0, s73, 65536
    v_mfma_f32_16x16x32_bf16 v[60:63], a[44:47], v[148:151], v[60:63]
    ds_read_b128 v[148:151], v200 offset:57344
    s_lshl_b32 s64, s64, 7
    v_mfma_f32_16x16x32_bf16 v[64:67], a[40:43], v[152:155], v[64:67]
    buffer_load_dwordx4 v194, s[24:27], s71 offen lds
    v_mfma_f32_16x16x32_bf16 v[68:71], a[44:47], v[152:155], v[68:71]
    ds_read_b128 v[152:155], v200 offset:59392
    s_add_u32 s64, s64, s0
    v_mfma_f32_16x16x32_bf16 v[72:75], a[40:43], v[156:159], v[72:75]
    buffer_load_dwordx4 v195, s[24:27], s71 offen offset:1024 lds
    v_mfma_f32_16x16x32_bf16 v[76:79], a[44:47], v[156:159], v[76:79]
    ds_read_b128 v[156:159], v200 offset:61440
    s_mul_i32 s74, s56, 10240
    v_mfma_f32_16x16x32_bf16 v[80:83], a[40:43], v[160:163], v[80:83]
    buffer_load_dwordx4 v196, s[24:27], s71 offen offset:2048 lds
    v_mfma_f32_16x16x32_bf16 v[84:87], a[44:47], v[160:163], v[84:87]
    ds_read_b128 v[160:163], v200 offset:63488
    s_and_b32 s19, s19, 1
    v_mfma_f32_16x16x32_bf16 v[88:91], a[40:43], v[164:167], v[88:91]
    buffer_load_dwordx4 v197, s[24:27], s71 offen offset:3072 lds
    v_mfma_f32_16x16x32_bf16 v[92:95], a[44:47], v[164:167], v[92:95]
    ds_read_b128 v[164:167], v201 offset:40960
    s_add_u32 m0, s72, 40960
    v_mfma_f32_16x16x32_bf16 v[96:99], a[40:43], v[168:171], v[96:99]
    buffer_load_dwordx4 v188, s[20:23], s51 offen lds
    v_mfma_f32_16x16x32_bf16 v[100:103], a[44:47], v[168:171], v[100:103]
    ds_read_b128 v[168:171], v201 offset:43008
    s_mul_i32 s65, s19, 40960
    v_mfma_f32_16x16x32_bf16 v[104:107], a[40:43], v[172:175], v[104:107]
    buffer_load_dwordx4 v189, s[20:23], s51 offen offset:1024 lds
    v_mfma_f32_16x16x32_bf16 v[108:111], a[44:47], v[172:175], v[108:111]
    ds_read_b128 v[172:175], v201 offset:45056
    s_sub_u32 s3, 40960, s65
    s_waitcnt lgkmcnt(3)
    v_mfma_f32_16x16x32_bf16 v[16:19], a[48:51], v[176:179], v[16:19]
    ds_read_b64_tr_b16 a[56:57], v203 offset:45056
    ds_read_b64_tr_b16 a[58:59], v203 offset:45568
    v_mfma_f32_16x16x32_bf16 v[20:23], a[52:55], v[176:179], v[20:23]
    ds_read_b128 v[176:179], v201 offset:47104
    s_mul_i32 s0, s19, 110592
    v_mfma_f32_16x16x32_bf16 v[24:27], a[48:51], v[180:183], v[24:27]
    ds_read_b64_tr_b16 a[60:61], v203 offset:53248
    ds_read_b64_tr_b16 a[62:63], v203 offset:53760
    v_mfma_f32_16x16x32_bf16 v[28:31], a[52:55], v[180:183], v[28:31]
    ds_read_b128 v[180:183], v201 offset:49152
    s_sub_u32 s1, 774144, s0
    v_mfma_f32_16x16x32_bf16 v[32:35], a[48:51], v[184:187], v[32:35]
    buffer_load_dwordx4 v190, s[20:23], s51 offen offset:2048 lds
    v_mfma_f32_16x16x32_bf16 v[36:39], a[52:55], v[184:187], v[36:39]
    ds_read_b128 v[184:187], v201 offset:51200
    s_add_u32 m0, s72, 44032
    v_mfma_f32_16x16x32_bf16 v[40:43], a[48:51], v[128:131], v[40:43]
    buffer_load_dwordx4 v191, s[20:23], s51 offen lds
    v_mfma_f32_16x16x32_bf16 v[44:47], a[52:55], v[128:131], v[44:47]
    ds_read_b128 v[128:131], v201 offset:53248
    s_add_u32 s0, s0, 663552
    v_mfma_f32_16x16x32_bf16 v[48:51], a[48:51], v[132:135], v[48:51]
    v_mov_b32 v15, 0
    v_mov_b32 v14, 0
    v_mfma_f32_16x16x32_bf16 v[52:55], a[52:55], v[132:135], v[52:55]
    ds_read_b128 v[132:135], v201 offset:55296
    v_mfma_f32_16x16x32_bf16 v[56:59], a[48:51], v[136:139], v[56:59]
    buffer_load_dwordx4 v192, s[20:23], s51 offen offset:1024 lds
    v_mfma_f32_16x16x32_bf16 v[60:63], a[52:55], v[136:139], v[60:63]
    ds_read_b128 v[136:139], v201 offset:57344
    v_mfma_f32_16x16x32_bf16 v[64:67], a[48:51], v[140:143], v[64:67]
    v_mfma_f32_16x16x32_bf16 v[68:71], a[52:55], v[140:143], v[68:71]
    ds_read_b128 v[140:143], v201 offset:59392
    v_mfma_f32_16x16x32_bf16 v[72:75], a[48:51], v[144:147], v[72:75]
    buffer_load_dwordx4 v193, s[20:23], s51 offen offset:2048 lds
    v_mfma_f32_16x16x32_bf16 v[76:79], a[52:55], v[144:147], v[76:79]
    ds_read_b128 v[144:147], v201 offset:61440
    v_mfma_f32_16x16x32_bf16 v[80:83], a[48:51], v[148:151], v[80:83]
    s_mul_i32 s71, s78, 1728
    s_add_u32 m0, s73, 106496
    v_mfma_f32_16x16x32_bf16 v[84:87], a[52:55], v[148:151], v[84:87]
    ds_read_b128 v[148:151], v201 offset:63488
    v_mfma_f32_16x16x32_bf16 v[88:91], a[48:51], v[152:155], v[88:91]
    buffer_load_dwordx4 v194, s[24:27], s71 offen lds
    v_mfma_f32_16x16x32_bf16 v[92:95], a[52:55], v[152:155], v[92:95]
    v_mfma_f32_16x16x32_bf16 v[96:99], a[48:51], v[156:159], v[96:99]
    v_mfma_f32_16x16x32_bf16 v[100:103], a[52:55], v[156:159], v[100:103]
    v_mfma_f32_16x16x32_bf16 v[104:107], a[48:51], v[160:163], v[104:107]
    buffer_load_dwordx4 v195, s[24:27], s71 offen offset:1024 lds
    v_mfma_f32_16x16x32_bf16 v[108:111], a[52:55], v[160:163], v[108:111]
    s_waitcnt vmcnt(12) lgkmcnt(0)
    s_barrier
    v_mfma_f32_16x16x32_bf16 v[16:19], a[56:59], v[164:167], v[16:19]
    ds_read_b128 v[152:155], v198 offset:0
    v_mfma_f32_16x16x32_bf16 v[20:23], a[60:63], v[164:167], v[20:23]
    ds_read_b128 v[156:159], v198 offset:2048
    v_mfma_f32_16x16x32_bf16 v[24:27], a[56:59], v[168:171], v[24:27]
    ds_read_b128 v[160:163], v198 offset:4096
    v_mfma_f32_16x16x32_bf16 v[28:31], a[60:63], v[168:171], v[28:31]
    ds_read_b128 v[164:167], v198 offset:6144
    v_mfma_f32_16x16x32_bf16 v[32:35], a[56:59], v[172:175], v[32:35]
    ds_read_b128 v[168:171], v198 offset:8192
    v_mfma_f32_16x16x32_bf16 v[36:39], a[60:63], v[172:175], v[36:39]
    ds_read_b128 v[172:175], v198 offset:10240
    v_mfma_f32_16x16x32_bf16 v[40:43], a[56:59], v[176:179], v[40:43]
    ds_read_b64_tr_b16 a[64:65], v202 offset:0
    ds_read_b64_tr_b16 a[66:67], v202 offset:512
    v_mfma_f32_16x16x32_bf16 v[44:47], a[60:63], v[176:179], v[44:47]
    ds_read_b128 v[176:179], v198 offset:12288
    v_mfma_f32_16x16x32_bf16 v[48:51], a[56:59], v[180:183], v[48:51]
    ds_read_b64_tr_b16 a[68:69], v202 offset:8192
    ds_read_b64_tr_b16 a[70:71], v202 offset:8704
    v_mfma_f32_16x16x32_bf16 v[52:55], a[60:63], v[180:183], v[52:55]
    ds_read_b128 v[180:183], v198 offset:14336
    v_mfma_f32_16x16x32_bf16 v[56:59], a[56:59], v[184:187], v[56:59]
    buffer_load_dwordx4 v196, s[24:27], s71 offen offset:2048 lds
    v_mfma_f32_16x16x32_bf16 v[60:63], a[60:63], v[184:187], v[60:63]
    ds_read_b128 v[184:187], v198 offset:16384
    v_mfma_f32_16x16x32_bf16 v[64:67], a[56:59], v[128:131], v[64:67]
    buffer_load_dwordx4 v197, s[24:27], s71 offen offset:3072 lds
    v_mfma_f32_16x16x32_bf16 v[68:71], a[60:63], v[128:131], v[68:71]
    ds_read_b128 v[128:131], v198 offset:18432
    s_add_u32 m0, s72, 81920
    v_mfma_f32_16x16x32_bf16 v[72:75], a[56:59], v[132:135], v[72:75]
    buffer_load_dwordx4 v188, s[20:23], s78 offen lds
    v_mfma_f32_16x16x32_bf16 v[76:79], a[60:63], v[132:135], v[76:79]
    ds_read_b128 v[132:135], v198 offset:20480
    v_mfma_f32_16x16x32_bf16 v[80:83], a[56:59], v[136:139], v[80:83]
    buffer_load_dwordx4 v189, s[20:23], s78 offen offset:1024 lds
    v_mfma_f32_16x16x32_bf16 v[84:87], a[60:63], v[136:139], v[84:87]
    ds_read_b128 v[136:139], v198 offset:22528
    v_mfma_f32_16x16x32_bf16 v[88:91], a[56:59], v[140:143], v[88:91]
    buffer_load_dwordx4 v190, s[20:23], s78 offen offset:2048 lds
    v_mfma_f32_16x16x32_bf16 v[92:95], a[60:63], v[140:143], v[92:95]
    ds_read_b128 v[140:143], v199 offset:0
    v_mfma_f32_16x16x32_bf16 v[96:99], a[56:59], v[144:147], v[96:99]
    s_add_u32 m0, s72, 84992
    v_mfma_f32_16x16x32_bf16 v[100:103], a[60:63], v[144:147], v[100:103]
    ds_read_b128 v[144:147], v199 offset:2048
    v_mfma_f32_16x16x32_bf16 v[104:107], a[56:59], v[148:151], v[104:107]
    buffer_load_dwordx4 v191, s[20:23], s78 offen lds
    v_mfma_f32_16x16x32_bf16 v[108:111], a[60:63], v[148:151], v[108:111]
    ds_read_b128 v[148:151], v199 offset:4096
    s_waitcnt lgkmcnt(3)
    v_mfma_f32_16x16x32_bf16 v[16:19], a[64:67], v[152:155], v[16:19]
    ds_read_b64_tr_b16 a[72:73], v202 offset:4096
    ds_read_b64_tr_b16 a[74:75], v202 offset:4608
    v_mfma_f32_16x16x32_bf16 v[20:23], a[68:71], v[152:155], v[20:23]
    ds_read_b128 v[152:155], v199 offset:6144
    v_mfma_f32_16x16x32_bf16 v[24:27], a[64:67], v[156:159], v[24:27]
    ds_read_b64_tr_b16 a[76:77], v202 offset:12288
    ds_read_b64_tr_b16 a[78:79], v202 offset:12800
    v_mfma_f32_16x16x32_bf16 v[28:31], a[68:71], v[156:159], v[28:31]
    ds_read_b128 v[156:159], v199 offset:8192
    v_mfma_f32_16x16x32_bf16 v[32:35], a[64:67], v[160:163], v[32:35]
    buffer_load_dwordx4 v192, s[20:23], s78 offen offset:1024 lds
    v_mfma_f32_16x16x32_bf16 v[36:39], a[68:71], v[160:163], v[36:39]
    ds_read_b128 v[160:163], v199 offset:10240
    v_mfma_f32_16x16x32_bf16 v[40:43], a[64:67], v[164:167], v[40:43]
    buffer_load_dwordx4 v193, s[20:23], s78 offen offset:2048 lds
    v_mfma_f32_16x16x32_bf16 v[44:47], a[68:71], v[164:167], v[44:47]
    ds_read_b128 v[164:167], v199 offset:12288
    v_mfma_f32_16x16x32_bf16 v[48:51], a[64:67], v[168:171], v[48:51]
    s_mul_i32 s71, s79, 1728
    s_add_u32 m0, s73, 147456
    v_mfma_f32_16x16x32_bf16 v[52:55], a[68:71], v[168:171], v[52:55]
    ds_read_b128 v[168:171], v199 offset:14336
    v_mfma_f32_16x16x32_bf16 v[56:59], a[64:67], v[172:175], v[56:59]
    buffer_load_dwordx4 v194, s[24:27], s71 offen lds
    v_mfma_f32_16x16x32_bf16 v[60:63], a[68:71], v[172:175], v[60:63]
    ds_read_b128 v[172:175], v199 offset:16384
    v_mfma_f32_16x16x32_bf16 v[64:67], a[64:67], v[176:179], v[64:67]
    v_mfma_f32_16x16x32_bf16 v[68:71], a[68:71], v[176:179], v[68:71]
    ds_read_b128 v[176:179], v199 offset:18432
    v_mfma_f32_16x16x32_bf16 v[72:75], a[64:67], v[180:183], v[72:75]
    buffer_load_dwordx4 v195, s[24:27], s71 offen offset:1024 lds
    v_mfma_f32_16x16x32_bf16 v[76:79], a[68:71], v[180:183], v[76:79]
    ds_read_b128 v[180:183], v199 offset:20480
    v_mfma_f32_16x16x32_bf16 v[80:83], a[64:67], v[184:187], v[80:83]
    v_mfma_f32_16x16x32_bf16 v[84:87], a[68:71], v[184:187], v[84:87]
    ds_read_b128 v[184:187], v199 offset:22528
    v_mfma_f32_16x16x32_bf16 v[88:91], a[64:67], v[128:131], v[88:91]
    buffer_load_dwordx4 v196, s[24:27], s71 offen offset:2048 lds
    v_mfma_f32_16x16x32_bf16 v[92:95], a[68:71], v[128:131], v[92:95]
    v_mfma_f32_16x16x32_bf16 v[96:99], a[64:67], v[132:135], v[96:99]
    v_mfma_f32_16x16x32_bf16 v[100:103], a[68:71], v[132:135], v[100:103]
    v_mfma_f32_16x16x32_bf16 v[104:107], a[64:67], v[136:139], v[104:107]
    buffer_load_dwordx4 v197, s[24:27], s71 offen offset:3072 lds
    v_mfma_f32_16x16x32_bf16 v[108:111], a[68:71], v[136:139], v[108:111]
    s_waitcnt vmcnt(14) lgkmcnt(0)
    s_barrier
    v_mfma_f32_16x16x32_bf16 v[16:19], a[72:75], v[140:143], v[16:19]
    ds_read_b128 v[128:131], v198 offset:40960
    s_add_u32 m0, s72, 122880
    v_mfma_f32_16x16x32_bf16 v[20:23], a[76:79], v[140:143], v[20:23]
    ds_read_b128 v[132:135], v198 offset:43008
    v_mfma_f32_16x16x32_bf16 v[24:27], a[72:75], v[144:147], v[24:27]
    ds_read_b128 v[136:139], v198 offset:45056
    v_mfma_f32_16x16x32_bf16 v[28:31], a[76:79], v[144:147], v[28:31]
    ds_read_b128 v[140:143], v198 offset:47104
    v_mfma_f32_16x16x32_bf16 v[32:35], a[72:75], v[148:151], v[32:35]
    ds_read_b128 v[144:147], v198 offset:49152
    v_mfma_f32_16x16x32_bf16 v[36:39], a[76:79], v[148:151], v[36:39]
    ds_read_b128 v[148:151], v198 offset:51200
    v_mfma_f32_16x16x32_bf16 v[40:43], a[72:75], v[152:155], v[40:43]
    ds_read_b64_tr_b16 a[80:81], v202 offset:40960
    ds_read_b64_tr_b16 a[82:83], v202 offset:41472
    v_mfma_f32_16x16x32_bf16 v[44:47], a[76:79], v[152:155], v[44:47]
    ds_read_b128 v[152:155], v198 offset:53248
    v_mfma_f32_16x16x32_bf16 v[48:51], a[72:75], v[156:159], v[48:51]
    ds_read_b64_tr_b16 a[84:85], v202 offset:49152
    ds_read_b64_tr_b16 a[86:87], v202 offset:49664
    v_mfma_f32_16x16x32_bf16 v[52:55], a[76:79], v[156:159], v[52:55]
    ds_read_b128 v[156:159], v198 offset:55296
    v_mfma_f32_16x16x32_bf16 v[56:59], a[72:75], v[160:163], v[56:59]
    buffer_load_dwordx4 v188, s[20:23], s79 offen lds
    v_mfma_f32_16x16x32_bf16 v[60:63], a[76:79], v[160:163], v[60:63]
    ds_read_b128 v[160:163], v198 offset:57344
    v_mfma_f32_16x16x32_bf16 v[64:67], a[72:75], v[164:167], v[64:67]
    buffer_load_dwordx4 v189, s[20:23], s79 offen offset:1024 lds
    v_mfma_f32_16x16x32_bf16 v[68:71], a[76:79], v[164:167], v[68:71]
    ds_read_b128 v[164:167], v198 offset:59392
    v_mfma_f32_16x16x32_bf16 v[72:75], a[72:75], v[168:171], v[72:75]
    buffer_load_dwordx4 v190, s[20:23], s79 offen offset:2048 lds
    v_mfma_f32_16x16x32_bf16 v[76:79], a[76:79], v[168:171], v[76:79]
    ds_read_b128 v[168:171], v198 offset:61440
    s_add_u32 m0, s72, 125952
    v_mfma_f32_16x16x32_bf16 v[80:83], a[72:75], v[172:175], v[80:83]
    buffer_load_dwordx4 v191, s[20:23], s79 offen lds
    v_mfma_f32_16x16x32_bf16 v[84:87], a[76:79], v[172:175], v[84:87]
    ds_read_b128 v[172:175], v198 offset:63488
    v_mfma_f32_16x16x32_bf16 v[88:91], a[72:75], v[176:179], v[88:91]
    buffer_load_dwordx4 v192, s[20:23], s79 offen offset:1024 lds
    v_mfma_f32_16x16x32_bf16 v[92:95], a[76:79], v[176:179], v[92:95]
    ds_read_b128 v[176:179], v199 offset:40960
    v_mfma_f32_16x16x32_bf16 v[96:99], a[72:75], v[180:183], v[96:99]
    v_mfma_f32_16x16x32_bf16 v[100:103], a[76:79], v[180:183], v[100:103]
    ds_read_b128 v[180:183], v199 offset:43008
    v_mfma_f32_16x16x32_bf16 v[104:107], a[72:75], v[184:187], v[104:107]
    buffer_load_dwordx4 v193, s[20:23], s79 offen offset:2048 lds
    v_mfma_f32_16x16x32_bf16 v[108:111], a[76:79], v[184:187], v[108:111]
    ds_read_b128 v[184:187], v199 offset:45056
    s_waitcnt lgkmcnt(3)
    v_mfma_f32_16x16x32_bf16 v[16:19], a[80:83], v[128:131], v[16:19]
    ds_read_b64_tr_b16 a[88:89], v202 offset:45056
    ds_read_b64_tr_b16 a[90:91], v202 offset:45568
    v_mfma_f32_16x16x32_bf16 v[20:23], a[84:87], v[128:131], v[20:23]
    ds_read_b128 v[128:131], v199 offset:47104
    v_mfma_f32_16x16x32_bf16 v[24:27], a[80:83], v[132:135], v[24:27]
    ds_read_b64_tr_b16 a[92:93], v202 offset:53248
    ds_read_b64_tr_b16 a[94:95], v202 offset:53760
    v_mfma_f32_16x16x32_bf16 v[28:31], a[84:87], v[132:135], v[28:31]
    ds_read_b128 v[132:135], v199 offset:49152
    v_mfma_f32_16x16x32_bf16 v[32:35], a[80:83], v[136:139], v[32:35]
    s_mul_i32 s71, s57, 1728
    s_add_u32 m0, s73, 24576
    v_mfma_f32_16x16x32_bf16 v[36:39], a[84:87], v[136:139], v[36:39]
    ds_read_b128 v[136:139], v199 offset:51200
    v_mfma_f32_16x16x32_bf16 v[40:43], a[80:83], v[140:143], v[40:43]
    buffer_load_dwordx4 v194, s[24:27], s71 offen lds
    v_mfma_f32_16x16x32_bf16 v[44:47], a[84:87], v[140:143], v[44:47]
    ds_read_b128 v[140:143], v199 offset:53248
    v_mfma_f32_16x16x32_bf16 v[48:51], a[80:83], v[144:147], v[48:51]
    buffer_load_dwordx4 v195, s[24:27], s71 offen offset:1024 lds
    v_mfma_f32_16x16x32_bf16 v[52:55], a[84:87], v[144:147], v[52:55]
    ds_read_b128 v[144:147], v199 offset:55296
    v_mfma_f32_16x16x32_bf16 v[56:59], a[80:83], v[148:151], v[56:59]
    buffer_load_dwordx4 v196, s[24:27], s71 offen offset:2048 lds
    v_mfma_f32_16x16x32_bf16 v[60:63], a[84:87], v[148:151], v[60:63]
    ds_read_b128 v[148:151], v199 offset:57344
    v_mfma_f32_16x16x32_bf16 v[64:67], a[80:83], v[152:155], v[64:67]
    v_mfma_f32_16x16x32_bf16 v[68:71], a[84:87], v[152:155], v[68:71]
    ds_read_b128 v[152:155], v199 offset:59392
    v_mfma_f32_16x16x32_bf16 v[72:75], a[80:83], v[156:159], v[72:75]
    buffer_load_dwordx4 v197, s[24:27], s71 offen offset:3072 lds
    v_mfma_f32_16x16x32_bf16 v[76:79], a[84:87], v[156:159], v[76:79]
    ds_read_b128 v[156:159], v199 offset:61440
    v_mfma_f32_16x16x32_bf16 v[80:83], a[80:83], v[160:163], v[80:83]
    s_add_u32 m0, s72, 0
    v_mfma_f32_16x16x32_bf16 v[84:87], a[84:87], v[160:163], v[84:87]
    ds_read_b128 v[160:163], v199 offset:63488
    v_mfma_f32_16x16x32_bf16 v[88:91], a[80:83], v[164:167], v[88:91]
    buffer_load_dwordx4 v188, s[20:23], s57 offen lds
    v_mfma_f32_16x16x32_bf16 v[92:95], a[84:87], v[164:167], v[92:95]
    v_mfma_f32_16x16x32_bf16 v[96:99], a[80:83], v[168:171], v[96:99]
    v_mfma_f32_16x16x32_bf16 v[100:103], a[84:87], v[168:171], v[100:103]
    v_mfma_f32_16x16x32_bf16 v[104:107], a[80:83], v[172:175], v[104:107]
    buffer_load_dwordx4 v189, s[20:23], s57 offen offset:1024 lds
    v_mfma_f32_16x16x32_bf16 v[108:111], a[84:87], v[172:175], v[108:111]
    s_waitcnt vmcnt(16) lgkmcnt(0)
    s_barrier
    v_mfma_f32_16x16x32_bf16 v[16:19], a[88:91], v[176:179], v[16:19]
    ds_read_b128 v[164:167], v200 offset:0
    v_mfma_f32_16x16x32_bf16 v[20:23], a[92:95], v[176:179], v[20:23]
    ds_read_b128 v[168:171], v200 offset:2048
    v_mfma_f32_16x16x32_bf16 v[24:27], a[88:91], v[180:183], v[24:27]
    ds_read_b128 v[172:175], v200 offset:4096
    v_mfma_f32_16x16x32_bf16 v[28:31], a[92:95], v[180:183], v[28:31]
    ds_read_b128 v[176:179], v200 offset:6144
    v_mfma_f32_16x16x32_bf16 v[32:35], a[88:91], v[184:187], v[32:35]
    ds_read_b128 v[180:183], v200 offset:8192
    v_mfma_f32_16x16x32_bf16 v[36:39], a[92:95], v[184:187], v[36:39]
    ds_read_b128 v[184:187], v200 offset:10240
    v_mfma_f32_16x16x32_bf16 v[40:43], a[88:91], v[128:131], v[40:43]
    ds_read_b64_tr_b16 a[96:97], v203 offset:0
    ds_read_b64_tr_b16 a[98:99], v203 offset:512
    v_mfma_f32_16x16x32_bf16 v[44:47], a[92:95], v[128:131], v[44:47]
    ds_read_b128 v[128:131], v200 offset:12288
    v_mfma_f32_16x16x32_bf16 v[48:51], a[88:91], v[132:135], v[48:51]
    ds_read_b64_tr_b16 a[100:101], v203 offset:8192
    ds_read_b64_tr_b16 a[102:103], v203 offset:8704
    v_mfma_f32_16x16x32_bf16 v[52:55], a[92:95], v[132:135], v[52:55]
    ds_read_b128 v[132:135], v200 offset:14336
    v_mfma_f32_16x16x32_bf16 v[56:59], a[88:91], v[136:139], v[56:59]
    buffer_load_dwordx4 v190, s[20:23], s57 offen offset:2048 lds
    v_mfma_f32_16x16x32_bf16 v[60:63], a[92:95], v[136:139], v[60:63]
    ds_read_b128 v[136:139], v200 offset:16384
    s_add_u32 m0, s72, 3072
    v_mfma_f32_16x16x32_bf16 v[64:67], a[88:91], v[140:143], v[64:67]
    buffer_load_dwordx4 v191, s[20:23], s57 offen lds
    v_mfma_f32_16x16x32_bf16 v[68:71], a[92:95], v[140:143], v[68:71]
    ds_read_b128 v[140:143], v200 offset:18432
    v_mfma_f32_16x16x32_bf16 v[72:75], a[88:91], v[144:147], v[72:75]
    buffer_load_dwordx4 v192, s[20:23], s57 offen offset:1024 lds
    v_mfma_f32_16x16x32_bf16 v[76:79], a[92:95], v[144:147], v[76:79]
    ds_read_b128 v[144:147], v200 offset:20480
    v_mfma_f32_16x16x32_bf16 v[80:83], a[88:91], v[148:151], v[80:83]
    buffer_load_dwordx4 v193, s[20:23], s57 offen offset:2048 lds
    v_mfma_f32_16x16x32_bf16 v[84:87], a[92:95], v[148:151], v[84:87]
    ds_read_b128 v[148:151], v200 offset:22528
    v_mfma_f32_16x16x32_bf16 v[88:91], a[88:91], v[152:155], v[88:91]
    s_mul_i32 s71, s58, 1728
    s_add_u32 m0, s73, 65536
    v_mfma_f32_16x16x32_bf16 v[92:95], a[92:95], v[152:155], v[92:95]
    ds_read_b128 v[152:155], v201 offset:0
    v_mfma_f32_16x16x32_bf16 v[96:99], a[88:91], v[156:159], v[96:99]
    buffer_load_dwordx4 v194, s[24:27], s71 offen lds
    v_mfma_f32_16x16x32_bf16 v[100:103], a[92:95], v[156:159], v[100:103]
    ds_read_b128 v[156:159], v201 offset:2048
    v_mfma_f32_16x16x32_bf16 v[104:107], a[88:91], v[160:163], v[104:107]
    buffer_load_dwordx4 v195, s[24:27], s71 offen offset:1024 lds
    v_mfma_f32_16x16x32_bf16 v[108:111], a[92:95], v[160:163], v[108:111]
    ds_read_b128 v[160:163], v201 offset:4096
    s_waitcnt lgkmcnt(3)
    v_mfma_f32_16x16x32_bf16 v[16:19], a[96:99], v[164:167], v[16:19]
    ds_read_b64_tr_b16 a[104:105], v203 offset:4096
    ds_read_b64_tr_b16 a[106:107], v203 offset:4608
    v_mfma_f32_16x16x32_bf16 v[20:23], a[100:103], v[164:167], v[20:23]
    ds_read_b128 v[164:167], v201 offset:6144
    v_mfma_f32_16x16x32_bf16 v[24:27], a[96:99], v[168:171], v[24:27]
    ds_read_b64_tr_b16 a[108:109], v203 offset:12288
    ds_read_b64_tr_b16 a[110:111], v203 offset:12800
    v_mfma_f32_16x16x32_bf16 v[28:31], a[100:103], v[168:171], v[28:31]
    ds_read_b128 v[168:171], v201 offset:8192
    v_mfma_f32_16x16x32_bf16 v[32:35], a[96:99], v[172:175], v[32:35]
    buffer_load_dwordx4 v196, s[24:27], s71 offen offset:2048 lds
    v_mfma_f32_16x16x32_bf16 v[36:39], a[100:103], v[172:175], v[36:39]
    ds_read_b128 v[172:175], v201 offset:10240
    v_mfma_f32_16x16x32_bf16 v[40:43], a[96:99], v[176:179], v[40:43]
    buffer_load_dwordx4 v197, s[24:27], s71 offen offset:3072 lds
    v_mfma_f32_16x16x32_bf16 v[44:47], a[100:103], v[176:179], v[44:47]
    ds_read_b128 v[176:179], v201 offset:12288
    v_mfma_f32_16x16x32_bf16 v[48:51], a[96:99], v[180:183], v[48:51]
    s_add_u32 m0, s72, 40960
    v_mfma_f32_16x16x32_bf16 v[52:55], a[100:103], v[180:183], v[52:55]
    ds_read_b128 v[180:183], v201 offset:14336
    v_mfma_f32_16x16x32_bf16 v[56:59], a[96:99], v[184:187], v[56:59]
    buffer_load_dwordx4 v188, s[20:23], s58 offen lds
    v_mfma_f32_16x16x32_bf16 v[60:63], a[100:103], v[184:187], v[60:63]
    ds_read_b128 v[184:187], v201 offset:16384
    v_mfma_f32_16x16x32_bf16 v[64:67], a[96:99], v[128:131], v[64:67]
    v_mfma_f32_16x16x32_bf16 v[68:71], a[100:103], v[128:131], v[68:71]
    ds_read_b128 v[128:131], v201 offset:18432
    v_mfma_f32_16x16x32_bf16 v[72:75], a[96:99], v[132:135], v[72:75]
    buffer_load_dwordx4 v189, s[20:23], s58 offen offset:1024 lds
    v_mfma_f32_16x16x32_bf16 v[76:79], a[100:103], v[132:135], v[76:79]
    ds_read_b128 v[132:135], v201 offset:20480
    v_mfma_f32_16x16x32_bf16 v[80:83], a[96:99], v[136:139], v[80:83]
    v_mfma_f32_16x16x32_bf16 v[84:87], a[100:103], v[136:139], v[84:87]
    ds_read_b128 v[136:139], v201 offset:22528
    v_mfma_f32_16x16x32_bf16 v[88:91], a[96:99], v[140:143], v[88:91]
    buffer_load_dwordx4 v190, s[20:23], s58 offen offset:2048 lds
    v_mfma_f32_16x16x32_bf16 v[92:95], a[100:103], v[140:143], v[92:95]
    v_mfma_f32_16x16x32_bf16 v[96:99], a[96:99], v[144:147], v[96:99]
    s_add_u32 m0, s72, 44032
    v_mfma_f32_16x16x32_bf16 v[100:103], a[100:103], v[144:147], v[100:103]
    v_mfma_f32_16x16x32_bf16 v[104:107], a[96:99], v[148:151], v[104:107]
    buffer_load_dwordx4 v191, s[20:23], s58 offen lds
    v_mfma_f32_16x16x32_bf16 v[108:111], a[100:103], v[148:151], v[108:111]
    s_waitcnt vmcnt(18) lgkmcnt(0)
    s_barrier
    v_mfma_f32_16x16x32_bf16 v[16:19], a[104:107], v[152:155], v[16:19]
    ds_read_b128 v[140:143], v200 offset:40960
    v_mfma_f32_16x16x32_bf16 v[20:23], a[108:111], v[152:155], v[20:23]
    ds_read_b128 v[144:147], v200 offset:43008
    v_mfma_f32_16x16x32_bf16 v[24:27], a[104:107], v[156:159], v[24:27]
    ds_read_b128 v[148:151], v200 offset:45056
    v_mfma_f32_16x16x32_bf16 v[28:31], a[108:111], v[156:159], v[28:31]
    ds_read_b128 v[152:155], v200 offset:47104
    v_mfma_f32_16x16x32_bf16 v[32:35], a[104:107], v[160:163], v[32:35]
    ds_read_b128 v[156:159], v200 offset:49152
    v_mfma_f32_16x16x32_bf16 v[36:39], a[108:111], v[160:163], v[36:39]
    ds_read_b128 v[160:163], v200 offset:51200
    v_mfma_f32_16x16x32_bf16 v[40:43], a[104:107], v[164:167], v[40:43]
    ds_read_b64_tr_b16 a[112:113], v203 offset:40960
    ds_read_b64_tr_b16 a[114:115], v203 offset:41472
    v_mfma_f32_16x16x32_bf16 v[44:47], a[108:111], v[164:167], v[44:47]
    ds_read_b128 v[164:167], v200 offset:53248
    v_mfma_f32_16x16x32_bf16 v[48:51], a[104:107], v[168:171], v[48:51]
    ds_read_b64_tr_b16 a[116:117], v203 offset:49152
    ds_read_b64_tr_b16 a[118:119], v203 offset:49664
    v_mfma_f32_16x16x32_bf16 v[52:55], a[108:111], v[168:171], v[52:55]
    ds_read_b128 v[168:171], v200 offset:55296
    v_mfma_f32_16x16x32_bf16 v[56:59], a[104:107], v[172:175], v[56:59]
    buffer_load_dwordx4 v192, s[20:23], s58 offen offset:1024 lds
    v_mfma_f32_16x16x32_bf16 v[60:63], a[108:111], v[172:175], v[60:63]
    ds_read_b128 v[172:175], v200 offset:57344
    v_mfma_f32_16x16x32_bf16 v[64:67], a[104:107], v[176:179], v[64:67]
    buffer_load_dwordx4 v193, s[20:23], s58 offen offset:2048 lds
    v_mfma_f32_16x16x32_bf16 v[68:71], a[108:111], v[176:179], v[68:71]
    ds_read_b128 v[176:179], v200 offset:59392
    v_mfma_f32_16x16x32_bf16 v[72:75], a[104:107], v[180:183], v[72:75]
    s_add_u32 s70, s60, s65
    s_add_u32 m0, s74, 81920
    v_mfma_f32_16x16x32_bf16 v[76:79], a[108:111], v[180:183], v[76:79]
    ds_read_b128 v[180:183], v200 offset:61440
    v_mfma_f32_16x16x32_bf16 v[80:83], a[104:107], v[184:187], v[80:83]
    buffer_load_dwordx4 v188, s[20:23], s70 offen lds
    v_mfma_f32_16x16x32_bf16 v[84:87], a[108:111], v[184:187], v[84:87]
    ds_read_b128 v[184:187], v200 offset:63488
    v_mfma_f32_16x16x32_bf16 v[88:91], a[104:107], v[128:131], v[88:91]
    buffer_load_dwordx4 v189, s[20:23], s70 offen offset:1024 lds
    v_mfma_f32_16x16x32_bf16 v[92:95], a[108:111], v[128:131], v[92:95]
    ds_read_b128 v[128:131], v201 offset:40960
    s_add_u32 s70, s61, s65
    v_mfma_f32_16x16x32_bf16 v[96:99], a[104:107], v[132:135], v[96:99]
    buffer_load_dwordx4 v188, s[20:23], s70 offen offset:2048 lds
    v_mfma_f32_16x16x32_bf16 v[100:103], a[108:111], v[132:135], v[100:103]
    ds_read_b128 v[132:135], v201 offset:43008
    v_mfma_f32_16x16x32_bf16 v[104:107], a[104:107], v[136:139], v[104:107]
    buffer_load_dwordx4 v189, s[20:23], s70 offen offset:3072 lds
    v_mfma_f32_16x16x32_bf16 v[108:111], a[108:111], v[136:139], v[108:111]
    ds_read_b128 v[136:139], v201 offset:45056
    s_waitcnt lgkmcnt(3)
    v_mfma_f32_16x16x32_bf16 v[16:19], a[112:115], v[140:143], v[16:19]
    ds_read_b64_tr_b16 a[120:121], v203 offset:45056
    ds_read_b64_tr_b16 a[122:123], v203 offset:45568
    v_mfma_f32_16x16x32_bf16 v[20:23], a[116:119], v[140:143], v[20:23]
    ds_read_b128 v[140:143], v201 offset:47104
    v_mfma_f32_16x16x32_bf16 v[24:27], a[112:115], v[144:147], v[24:27]
    ds_read_b64_tr_b16 a[124:125], v203 offset:53248
    ds_read_b64_tr_b16 a[126:127], v203 offset:53760
    v_mfma_f32_16x16x32_bf16 v[28:31], a[116:119], v[144:147], v[28:31]
    ds_read_b128 v[144:147], v201 offset:49152
    v_mfma_f32_16x16x32_bf16 v[32:35], a[112:115], v[148:151], v[32:35]
    s_add_u32 s70, s62, s65
    s_add_u32 m0, s74, 86016
    v_mfma_f32_16x16x32_bf16 v[36:39], a[116:119], v[148:151], v[36:39]
    ds_read_b128 v[148:151], v201 offset:51200
    v_mfma_f32_16x16x32_bf16 v[40:43], a[112:115], v[152:155], v[40:43]
    buffer_load_dwordx4 v188, s[20:23], s70 offen lds
    v_mfma_f32_16x16x32_bf16 v[44:47], a[116:119], v[152:155], v[44:47]
    ds_read_b128 v[152:155], v201 offset:53248
    v_mfma_f32_16x16x32_bf16 v[48:51], a[112:115], v[156:159], v[48:51]
    buffer_load_dwordx4 v189, s[20:23], s70 offen offset:1024 lds
    v_mfma_f32_16x16x32_bf16 v[52:55], a[116:119], v[156:159], v[52:55]
    ds_read_b128 v[156:159], v201 offset:55296
    s_add_u32 s70, s63, s65
    v_mfma_f32_16x16x32_bf16 v[56:59], a[112:115], v[160:163], v[56:59]
    buffer_load_dwordx4 v188, s[20:23], s70 offen offset:2048 lds
    v_mfma_f32_16x16x32_bf16 v[60:63], a[116:119], v[160:163], v[60:63]
    ds_read_b128 v[160:163], v201 offset:57344
    v_mfma_f32_16x16x32_bf16 v[64:67], a[112:115], v[164:167], v[64:67]
    global_load_dword v15, v15, s[46:47] offset:128 sc1
    v_mfma_f32_16x16x32_bf16 v[68:71], a[116:119], v[164:167], v[68:71]
    ds_read_b128 v[164:167], v201 offset:59392
    v_mfma_f32_16x16x32_bf16 v[72:75], a[112:115], v[168:171], v[72:75]
    buffer_load_dwordx4 v189, s[20:23], s70 offen offset:3072 lds
    v_mfma_f32_16x16x32_bf16 v[76:79], a[116:119], v[168:171], v[76:79]
    ds_read_b128 v[168:171], v201 offset:61440
    v_mfma_f32_16x16x32_bf16 v[80:83], a[112:115], v[172:175], v[80:83]
    s_add_u32 s70, s64, s65
    s_add_u32 m0, s74, 90112
    v_mfma_f32_16x16x32_bf16 v[84:87], a[116:119], v[172:175], v[84:87]
    ds_read_b128 v[172:175], v201 offset:63488
    v_mfma_f32_16x16x32_bf16 v[88:91], a[112:115], v[176:179], v[88:91]
    buffer_load_dwordx4 v188, s[20:23], s70 offen lds
    v_mfma_f32_16x16x32_bf16 v[92:95], a[116:119], v[176:179], v[92:95]
    v_mfma_f32_16x16x32_bf16 v[96:99], a[112:115], v[180:183], v[96:99]
    v_mfma_f32_16x16x32_bf16 v[100:103], a[116:119], v[180:183], v[100:103]
    v_mfma_f32_16x16x32_bf16 v[104:107], a[112:115], v[184:187], v[104:107]
    buffer_load_dwordx4 v189, s[20:23], s70 offen offset:1024 lds
    v_mfma_f32_16x16x32_bf16 v[108:111], a[116:119], v[184:187], v[108:111]
    s_waitcnt vmcnt(21) lgkmcnt(0)
    s_barrier
    v_mfma_f32_16x16x32_bf16 v[16:19], a[120:123], v[128:131], v[16:19]
    ds_read_b128 v[176:179], v198 offset:0
    v_mfma_f32_16x16x32_bf16 v[20:23], a[124:127], v[128:131], v[20:23]
    ds_read_b128 v[180:183], v198 offset:2048
    v_mfma_f32_16x16x32_bf16 v[24:27], a[120:123], v[132:135], v[24:27]
    ds_read_b128 v[184:187], v198 offset:4096
    v_mfma_f32_16x16x32_bf16 v[28:31], a[124:127], v[132:135], v[28:31]
    ds_read_b128 v[128:131], v198 offset:6144
    v_mfma_f32_16x16x32_bf16 v[32:35], a[120:123], v[136:139], v[32:35]
    ds_read_b128 v[132:135], v198 offset:8192
    v_mfma_f32_16x16x32_bf16 v[36:39], a[124:127], v[136:139], v[36:39]
    ds_read_b128 v[136:139], v198 offset:10240
    v_mfma_f32_16x16x32_bf16 v[40:43], a[120:123], v[140:143], v[40:43]
    ds_read_b64_tr_b16 a[128:129], v202 offset:0
    ds_read_b64_tr_b16 a[130:131], v202 offset:512
    v_mfma_f32_16x16x32_bf16 v[44:47], a[124:127], v[140:143], v[44:47]
    ds_read_b128 v[140:143], v198 offset:12288
    v_mfma_f32_16x16x32_bf16 v[48:51], a[120:123], v[144:147], v[48:51]
    ds_read_b64_tr_b16 a[132:133], v202 offset:8192
    ds_read_b64_tr_b16 a[134:135], v202 offset:8704
    v_mfma_f32_16x16x32_bf16 v[52:55], a[124:127], v[144:147], v[52:55]
    ds_read_b128 v[144:147], v198 offset:14336
    v_mfma_f32_16x16x32_bf16 v[56:59], a[120:123], v[148:151], v[56:59]
    s_add_u32 s70, s60, s3
    s_add_u32 m0, s74, 122880
    v_mfma_f32_16x16x32_bf16 v[60:63], a[124:127], v[148:151], v[60:63]
    ds_read_b128 v[148:151], v198 offset:16384
    v_mfma_f32_16x16x32_bf16 v[64:67], a[120:123], v[152:155], v[64:67]
    buffer_load_dwordx4 v188, s[20:23], s70 offen lds
    v_mfma_f32_16x16x32_bf16 v[68:71], a[124:127], v[152:155], v[68:71]
    ds_read_b128 v[152:155], v198 offset:18432
    v_mfma_f32_16x16x32_bf16 v[72:75], a[120:123], v[156:159], v[72:75]
    buffer_load_dwordx4 v189, s[20:23], s70 offen offset:1024 lds
L_pad1:
    s_cbranch_execz L_padret
    v_mfma_f32_16x16x32_bf16 v[76:79], a[124:127], v[156:159], v[76:79]
    ds_read_b128 v[156:159], v198 offset:20480
    s_add_u32 s70, s61, s3
    v_mfma_f32_16x16x32_bf16 v[80:83], a[120:123], v[160:163], v[80:83]
    buffer_load_dwordx4 v188, s[20:23], s70 offen offset:2048 lds
    v_mfma_f32_16x16x32_bf16 v[84:87], a[124:127], v[160:163], v[84:87]
    ds_read_b128 v[160:163], v198 offset:22528
    v_mfma_f32_16x16x32_bf16 v[88:91], a[120:123], v[164:167], v[88:91]
    buffer_load_dwordx4 v189, s[20:23], s70 offen offset:3072 lds
    v_mfma_f32_16x16x32_bf16 v[92:95], a[124:127], v[164:167], v[92:95]
    ds_read_b128 v[164:167], v199 offset:0
    v_mfma_f32_16x16x32_bf16 v[96:99], a[120:123], v[168:171], v[96:99]
    s_add_u32 s70, s62, s3
    s_add_u32 m0, s74, 126976
    v_mfma_f32_16x16x32_bf16 v[100:103], a[124:127], v[168:171], v[100:103]
    ds_read_b128 v[168:171], v199 offset:2048
    v_mfma_f32_16x16x32_bf16 v[104:107], a[120:123], v[172:175], v[104:107]
    buffer_load_dwordx4 v188, s[20:23], s70 offen lds
    v_mfma_f32_16x16x32_bf16 v[108:111], a[124:127], v[172:175], v[108:111]
    ds_read_b128 v[172:175], v199 offset:4096
    s_waitcnt lgkmcnt(3)
    v_mfma_f32_16x16x32_bf16 v[16:19], a[128:131], v[176:179], v[16:19]
    ds_read_b64_tr_b16 a[136:137], v202 offset:4096
    ds_read_b64_tr_b16 a[138:139], v202 offset:4608
    v_mfma_f32_16x16x32_bf16 v[20:23], a[132:135], v[176:179], v[20:23]
    ds_read_b128 v[176:179], v199 offset:6144
    v_mfma_f32_16x16x32_bf16 v[24:27], a[128:131], v[180:183], v[24:27]
    ds_read_b64_tr_b16 a[140:141], v202 offset:12288
    ds_read_b64_tr_b16 a[142:143], v202 offset:12800
    v_mfma_f32_16x16x32_bf16 v[28:31], a[132:135], v[180:183], v[28:31]
    ds_read_b128 v[180:183], v199 offset:8192
    v_mfma_f32_16x16x32_bf16 v[32:35], a[128:131], v[184:187], v[32:35]
    buffer_load_dwordx4 v189, s[20:23], s70 offen offset:1024 lds
    v_mfma_f32_16x16x32_bf16 v[36:39], a[132:135], v[184:187], v[36:39]
    ds_read_b128 v[184:187], v199 offset:10240
    s_add_u32 s70, s63, s3
    v_mfma_f32_16x16x32_bf16 v[40:43], a[128:131], v[128:131], v[40:43]
    buffer_load_dwordx4 v188, s[20:23], s70 offen offset:2048 lds
    v_mfma_f32_16x16x32_bf16 v[44:47], a[132:135], v[128:131], v[44:47]
    ds_read_b128 v[128:131], v199 offset:12288
    v_mfma_f32_16x16x32_bf16 v[48:51], a[128:131], v[132:135], v[48:51]
    buffer_load_dwordx4 v189, s[20:23], s70 offen offset:3072 lds
    v_mfma_f32_16x16x32_bf16 v[52:55], a[132:135], v[132:135], v[52:55]
    ds_read_b128 v[132:135], v199 offset:14336
    s_waitcnt vmcnt(11)
    v_readfirstlane_b32 s59, v15
    v_mfma_f32_16x16x32_bf16 v[56:59], a[128:131], v[136:139], v[56:59]
    s_add_u32 s70, s64, s3
    s_add_u32 m0, s74, 131072
    v_mfma_f32_16x16x32_bf16 v[60:63], a[132:135], v[136:139], v[60:63]
    ds_read_b128 v[136:139], v199 offset:16384
    v_cmp_eq_u32 vcc, 0, v15
    v_mfma_f32_16x16x32_bf16 v[64:67], a[128:131], v[140:143], v[64:67]
    buffer_load_dwordx4 v188, s[20:23], s70 offen lds
    v_mfma_f32_16x16x32_bf16 v[68:71], a[132:135], v[140:143], v[68:71]
    ds_read_b128 v[140:143], v199 offset:18432
    s_cbranch_vccnz L_wdslow
L_wdback:
    v_mfma_f32_16x16x32_bf16 v[72:75], a[128:131], v[144:147], v[72:75]
    buffer_load_dwordx4 v189, s[20:23], s70 offen offset:1024 lds
    v_mfma_f32_16x16x32_bf16 v[76:79], a[132:135], v[144:147], v[76:79]
    ds_read_b128 v[144:147], v199 offset:20480
    v_mfma_f32_16x16x32_bf16 v[80:83], a[128:131], v[148:151], v[80:83]
    buffer_load_dwordx4 a[160:163], v8, s[32:35], s4 offen sc1
    v_mfma_f32_16x16x32_bf16 v[84:87], a[132:135], v[148:151], v[84:87]
    ds_read_b128 v[148:151], v199 offset:22528
    v_mfma_f32_16x16x32_bf16 v[88:91], a[128:131], v[152:155], v[88:91]
    v_mfma_f32_16x16x32_bf16 v[92:95], a[132:135], v[152:155], v[92:95]
    v_mfma_f32_16x16x32_bf16 v[96:99], a[128:131], v[156:159], v[96:99]
    buffer_load_dwordx4 a[164:167], v9, s[32:35], s4 offen sc1
    v_mfma_f32_16x16x32_bf16 v[100:103], a[132:135], v[156:159], v[100:103]
    v_mfma_f32_16x16x32_bf16 v[104:107], a[128:131], v[160:163], v[104:107]
    v_mfma_f32_16x16x32_bf16 v[108:111], a[132:135], v[160:163], v[108:111]
    s_barrier
    s_waitcnt lgkmcnt(3)
    v_mfma_f32_16x16x32_bf16 v[16:19], a[136:139], v[164:167], v[16:19]
    ds_read_b128 v[152:155], v198 offset:40960
    v_mfma_f32_16x16x32_bf16 v[20:23], a[140:143], v[164:167], v[20:23]
    ds_read_b128 v[156:159], v199 offset:40960
    v_mfma_f32_16x16x32_bf16 v[24:27], a[136:139], v[168:171], v[24:27]
    ds_read_b128 v[160:163], v198 offset:43008
    v_mfma_f32_16x16x32_bf16 v[28:31], a[140:143], v[168:171], v[28:31]
    ds_read_b128 v[164:167], v199 offset:43008
    v_mfma_f32_16x16x32_bf16 v[32:35], a[136:139], v[172:175], v[32:35]
    ds_read_b128 v[168:171], v198 offset:45056
    v_mfma_f32_16x16x32_bf16 v[36:39], a[140:143], v[172:175], v[36:39]
    ds_read_b128 v[172:175], v199 offset:45056
    v_mfma_f32_16x16x32_bf16 v[40:43], a[136:139], v[176:179], v[40:43]
    ds_read_b64_tr_b16 a[144:145], v202 offset:40960
    ds_read_b64_tr_b16 a[146:147], v202 offset:41472
    v_mfma_f32_16x16x32_bf16 v[44:47], a[140:143], v[176:179], v[44:47]
    ds_read_b128 v[176:179], v198 offset:47104
    v_mfma_f32_16x16x32_bf16 v[48:51], a[136:139], v[180:183], v[48:51]
    ds_read_b64_tr_b16 a[148:149], v202 offset:49152
    ds_read_b64_tr_b16 a[150:151], v202 offset:49664
    v_mfma_f32_16x16x32_bf16 v[52:55], a[140:143], v[180:183], v[52:55]
    ds_read_b128 v[180:183], v199 offset:47104
    v_mfma_f32_16x16x32_bf16 v[56:59], a[136:139], v[184:187], v[56:59]
    ds_read_b64_tr_b16 a[152:153], v202 offset:45056
    ds_read_b64_tr_b16 a[154:155], v202 offset:45568
    v_mfma_f32_16x16x32_bf16 v[60:63], a[140:143], v[184:187], v[60:63]
    ds_read_b128 v[184:187], v198 offset:49152
    v_mfma_f32_16x16x32_bf16 v[64:67], a[136:139], v[128:131], v[64:67]
    ds_read_b64_tr_b16 a[156:157], v202 offset:53248
    ds_read_b64_tr_b16 a[158:159], v202 offset:53760
    v_mfma_f32_16x16x32_bf16 v[68:71], a[140:143], v[128:131], v[68:71]
    ds_read_b128 v[128:131], v199 offset:49152
    v_mfma_f32_16x16x32_bf16 v[72:75], a[136:139], v[132:135], v[72:75]
    buffer_load_dwordx4 a[168:171], v10, s[32:35], s4 offen sc1
    v_mfma_f32_16x16x32_bf16 v[76:79], a[140:143], v[132:135], v[76:79]
    ds_read_b128 v[132:135], v198 offset:51200
    v_mfma_f32_16x16x32_bf16 v[80:83], a[136:139], v[136:139], v[80:83]
    v_mfma_f32_16x16x32_bf16 v[84:87], a[140:143], v[136:139], v[84:87]
    ds_read_b128 v[136:139], v199 offset:51200
    s_waitcnt lgkmcnt(3)
    v_mfma_f32_16x16x32_bf16 v[88:91], a[136:139], v[140:143], v[88:91]
    buffer_load_dwordx4 a[172:175], v11, s[32:35], s4 offen sc1
    v_mfma_f32_16x16x32_bf16 v[92:95], a[140:143], v[140:143], v[92:95]
    ds_read_b128 v[140:143], v198 offset:53248
    v_mfma_f32_16x16x32_bf16 v[96:99], a[136:139], v[144:147], v[96:99]
    v_mfma_f32_16x16x32_bf16 v[100:103], a[140:143], v[144:147], v[100:103]
    ds_read_b128 v[144:147], v199 offset:53248
    v_mfma_f32_16x16x32_bf16 v[104:107], a[136:139], v[148:151], v[104:107]
    buffer_load_dwordx4 a[176:179], v12, s[32:35], s4 offen sc1
    v_mfma_f32_16x16x32_bf16 v[108:111], a[140:143], v[148:151], v[108:111]
    ds_read_b128 v[148:151], v198 offset:55296
    v_mfma_f32_16x16x32_bf16 v[16:19], a[144:147], v[152:155], v[16:19]
    v_mfma_f32_16x16x32_bf16 v[20:23], a[148:151], v[152:155], v[20:23]
    ds_read_b128 v[152:155], v199 offset:55296
    v_mfma_f32_16x16x32_bf16 v[16:19], a[152:155], v[156:159], v[16:19]
    buffer_load_dwordx4 a[180:183], v8, s[32:35], s5 offen sc1
    v_mfma_f32_16x16x32_bf16 v[20:23], a[156:159], v[156:159], v[20:23]
    ds_read_b128 v[156:159], v198 offset:57344
    v_mfma_f32_16x16x32_bf16 v[24:27], a[144:147], v[160:163], v[24:27]
    v_mfma_f32_16x16x32_bf16 v[28:31], a[148:151], v[160:163], v[28:31]
    ds_read_b128 v[160:163], v199 offset:57344
    v_mfma_f32_16x16x32_bf16 v[24:27], a[152:155], v[164:167], v[24:27]
    buffer_load_dwordx4 a[184:187], v9, s[32:35], s5 offen sc1
    v_mfma_f32_16x16x32_bf16 v[28:31], a[156:159], v[164:167], v[28:31]
    ds_read_b128 v[164:167], v198 offset:59392
    v_mfma_f32_16x16x32_bf16 v[32:35], a[144:147], v[168:171], v[32:35]
    v_mfma_f32_16x16x32_bf16 v[36:39], a[148:151], v[168:171], v[36:39]
    ds_read_b128 v[168:171], v199 offset:59392
    v_mfma_f32_16x16x32_bf16 v[32:35], a[152:155], v[172:175], v[32:35]
    buffer_load_dwordx4 a[188:191], v10, s[32:35], s5 offen sc1
    v_mfma_f32_16x16x32_bf16 v[36:39], a[156:159], v[172:175], v[36:39]
    ds_read_b128 v[172:175], v198 offset:61440
    v_mfma_f32_16x16x32_bf16 v[40:43], a[144:147], v[176:179], v[40:43]
    v_mfma_f32_16x16x32_bf16 v[44:47], a[148:151], v[176:179], v[44:47]
    ds_read_b128 v[176:179], v199 offset:61440
    v_mfma_f32_16x16x32_bf16 v[40:43], a[152:155], v[180:183], v[40:43]
    buffer_load_dwordx4 a[192:195], v11, s[32:35], s5 offen sc1
    v_mfma_f32_16x16x32_bf16 v[44:47], a[156:159], v[180:183], v[44:47]
    ds_read_b128 v[180:183], v198 offset:63488
    v_mul_f32 v16, v16, v20
    v_mul_f32 v17, v17, v21
    v_mul_f32 v18, v18, v22
    v_mfma_f32_16x16x32_bf16 v[48:51], a[144:147], v[184:187], v[48:51]
    v_mul_f32 v19, v19, v23
    v_mul_f32 v24, v24, v28
    v_mul_f32 v25, v25, v29
    v_mul_f32 v26, v26, v30
    v_mfma_f32_16x16x32_bf16 v[52:55], a[148:151], v[184:187], v[52:55]
    v_mul_f32 v27, v27, v31
    v_cvt_pk_bf16_f32 v20, v16, v17
    s_waitcnt vmcnt(19)
    s_barrier
    s_waitcnt lgkmcnt(3)
    v_mfma_f32_16x16x32_bf16 v[48:51], a[152:155], v[128:131], v[48:51]
    ds_read_b128 v[184:187], v199 offset:63488
    v_cvt_pk_bf16_f32 v21, v18, v19
    v_cvt_pk_bf16_f32 v22, v24, v25
    v_cvt_pk_bf16_f32 v23, v26, v27
    v_mfma_f32_16x16x32_bf16 v[52:55], a[156:159], v[128:131], v[52:55]
    ds_read_b128 v[128:131], v200 offset:0
    v_add_u32 v198, 122880, v198
    s_mov_b32 s18, 0
    v_mfma_f32_16x16x32_bf16 v[56:59], a[144:147], v[132:135], v[56:59]
    v_add_u32 v199, 122880, v199
    v_permlane16_swap_b32 v20, v22
    v_mfma_f32_16x16x32_bf16 v[60:63], a[148:151], v[132:135], v[60:63]
    ds_read_b128 v[132:135], v200 offset:20480
    v_permlane16_swap_b32 v21, v23
    v_mfma_f32_16x16x32_bf16 v[56:59], a[152:155], v[136:139], v[56:59]
    buffer_load_dwordx4 a[196:199], v12, s[32:35], s5 offen sc1
    buffer_store_dwordx4 v[20:23], v204, s[28:31], s18 offen sc1
    v_mfma_f32_16x16x32_bf16 v[60:63], a[156:159], v[136:139], v[60:63]
    ds_read_b128 v[136:139], v201 offset:0
    v_mul_f32 v32, v32, v36
    v_mul_f32 v33, v33, v37
    v_mul_f32 v34, v34, v38
    v_mfma_f32_16x16x32_bf16 v[64:67], a[144:147], v[140:143], v[64:67]
    v_mul_f32 v35, v35, v39
    v_mul_f32 v40, v40, v44
    v_mul_f32 v41, v41, v45
    v_mul_f32 v42, v42, v46
    v_mfma_f32_16x16x32_bf16 v[68:71], a[148:151], v[140:143], v[68:71]
    ds_read_b128 v[140:143], v201 offset:20480
    v_mul_f32 v43, v43, v47
    v_cvt_pk_bf16_f32 v36, v32, v33
    v_cvt_pk_bf16_f32 v37, v34, v35
    v_mfma_f32_16x16x32_bf16 v[64:67], a[152:155], v[144:147], v[64:67]
    buffer_load_dwordx4 a[200:203], v8, s[32:35], s6 offen sc1
    v_cvt_pk_bf16_f32 v38, v40, v41
    v_cvt_pk_bf16_f32 v39, v42, v43
    v_mfma_f32_16x16x32_bf16 v[68:71], a[156:159], v[144:147], v[68:71]
    ds_read_b128 v[144:147], v200 offset:2048
    s_mov_b32 s18, 110592
    v_mfma_f32_16x16x32_bf16 v[72:75], a[144:147], v[148:151], v[72:75]
    v_permlane16_swap_b32 v36, v38
    v_permlane16_swap_b32 v37, v39
    v_mfma_f32_16x16x32_bf16 v[76:79], a[148:151], v[148:151], v[76:79]
    ds_read_b128 v[148:151], v200 offset:22528
    buffer_store_dwordx4 v[36:39], v204, s[28:31], s18 offen sc1
    v_mfma_f32_16x16x32_bf16 v[72:75], a[152:155], v[152:155], v[72:75]
    buffer_load_dwordx4 a[204:207], v9, s[32:35], s6 offen sc1
    v_mfma_f32_16x16x32_bf16 v[76:79], a[156:159], v[152:155], v[76:79]
    ds_read_b128 v[152:155], v201 offset:2048
    v_mul_f32 v48, v48, v52
    v_mul_f32 v49, v49, v53
    v_mul_f32 v50, v50, v54
    v_mfma_f32_16x16x32_bf16 v[80:83], a[144:147], v[156:159], v[80:83]
    v_mul_f32 v51, v51, v55
    v_mul_f32 v56, v56, v60
    v_mul_f32 v57, v57, v61
    v_mul_f32 v58, v58, v62
    v_mfma_f32_16x16x32_bf16 v[84:87], a[148:151], v[156:159], v[84:87]
    ds_read_b128 v[156:159], v201 offset:22528
    v_mul_f32 v59, v59, v63
    v_cvt_pk_bf16_f32 v52, v48, v49
    v_cvt_pk_bf16_f32 v53, v50, v51
    v_mfma_f32_16x16x32_bf16 v[80:83], a[152:155], v[160:163], v[80:83]
    buffer_load_dwordx4 a[208:211], v10, s[32:35], s6 offen sc1
    v_cvt_pk_bf16_f32 v54, v56, v57
    v_cvt_pk_bf16_f32 v55, v58, v59
    v_mfma_f32_16x16x32_bf16 v[84:87], a[156:159], v[160:163], v[84:87]
    ds_read_b128 v[160:163], v200 offset:4096
    s_mov_b32 s18, 221184
    v_mfma_f32_16x16x32_bf16 v[88:91], a[144:147], v[164:167], v[88:91]
    v_permlane16_swap_b32 v52, v54
    v_permlane16_swap_b32 v53, v55
    v_mfma_f32_16x16x32_bf16 v[92:95], a[148:151], v[164:167], v[92:95]
    ds_read_b128 v[164:167], v200 offset:24576
    buffer_store_dwordx4 v[52:55], v204, s[28:31], s18 offen sc1
    v_mfma_f32_16x16x32_bf16 v[88:91], a[152:155], v[168:171], v[88:91]
    buffer_load_dwordx4 a[212:215], v11, s[32:35], s6 offen sc1
    v_mfma_f32_16x16x32_bf16 v[92:95], a[156:159], v[168:171], v[92:95]
    ds_read_b128 v[168:171], v201 offset:4096
    v_mul_f32 v64, v64, v68
    v_mul_f32 v65, v65, v69
    v_mul_f32 v66, v66, v70
    s_waitcnt lgkmcnt(3)
    v_mfma_f32_16x16x32_bf16 v[96:99], a[144:147], v[172:175], v[96:99]
    v_mul_f32 v67, v67, v71
    v_mul_f32 v72, v72, v76
    v_mul_f32 v73, v73, v77
    v_mul_f32 v74, v74, v78
    v_mfma_f32_16x16x32_bf16 v[100:103], a[148:151], v[172:175], v[100:103]
    ds_read_b128 v[172:175], v201 offset:24576
    v_mul_f32 v75, v75, v79
    v_cvt_pk_bf16_f32 v68, v64, v65
    v_cvt_pk_bf16_f32 v69, v66, v67
    v_mfma_f32_16x16x32_bf16 v[96:99], a[152:155], v[176:179], v[96:99]
    buffer_load_dwordx4 a[216:219], v12, s[32:35], s6 offen sc1
    v_cvt_pk_bf16_f32 v70, v72, v73
    v_cvt_pk_bf16_f32 v71, v74, v75
    v_mfma_f32_16x16x32_bf16 v[100:103], a[156:159], v[176:179], v[100:103]
    ds_read_b128 v[176:179], v200 offset:6144
    s_mov_b32 s18, 331776
    v_mfma_f32_16x16x32_bf16 v[104:107], a[144:147], v[180:183], v[104:107]
    v_permlane16_swap_b32 v68, v70
    v_permlane16_swap_b32 v69, v71
    v_mfma_f32_16x16x32_bf16 v[108:111], a[148:151], v[180:183], v[108:111]
    ds_read_b128 v[180:183], v200 offset:26624
    buffer_store_dwordx4 v[68:71], v204, s[28:31], s18 offen sc1
    v_mfma_f32_16x16x32_bf16 v[104:107], a[152:155], v[184:187], v[104:107]
    buffer_load_dwordx4 a[220:223], v8, s[32:35], s7 offen sc1
    v_mfma_f32_16x16x32_bf16 v[108:111], a[156:159], v[184:187], v[108:111]
    ds_read_b128 v[184:187], v201 offset:6144
    v_mul_f32 v80, v80, v84
    v_mul_f32 v81, v81, v85
    v_mul_f32 v82, v82, v86
    v_mfma_f32_16x16x32_bf16 v[112:115], a[0:3], v[128:131], 0
    v_mul_f32 v83, v83, v87
    v_mul_f32 v88, v88, v92
    v_mul_f32 v89, v89, v93
    v_mul_f32 v90, v90, v94
    v_mfma_f32_16x16x32_bf16 v[116:119], a[4:7], v[128:131], 0
    ds_read_b128 v[128:131], v201 offset:26624
    v_mul_f32 v91, v91, v95
    v_cvt_pk_bf16_f32 v84, v80, v81
    v_cvt_pk_bf16_f32 v85, v82, v83
    v_mfma_f32_16x16x32_bf16 v[120:123], a[0:3], v[132:135], 0
    buffer_load_dwordx4 a[224:227], v9, s[32:35], s7 offen sc1
    v_cvt_pk_bf16_f32 v86, v88, v89
    v_cvt_pk_bf16_f32 v87, v90, v91
    v_mfma_f32_16x16x32_bf16 v[124:127], a[4:7], v[132:135], 0
    ds_read_b128 v[132:135], v200 offset:8192
    s_mov_b32 s18, 442368
    v_mfma_f32_16x16x32_bf16 v[112:115], a[8:11], v[136:139], v[112:115]
    v_permlane16_swap_b32 v84, v86
    v_permlane16_swap_b32 v85, v87
    v_mfma_f32_16x16x32_bf16 v[116:119], a[12:15], v[136:139], v[116:119]
    ds_read_b128 v[136:139], v200 offset:28672
    buffer_store_dwordx4 v[84:87], v204, s[28:31], s18 offen sc1
    v_mfma_f32_16x16x32_bf16 v[120:123], a[8:11], v[140:143], v[120:123]
    buffer_load_dwordx4 a[228:231], v10, s[32:35], s7 offen sc1
    v_mfma_f32_16x16x32_bf16 v[124:127], a[12:15], v[140:143], v[124:127]
    ds_read_b128 v[140:143], v201 offset:8192
    v_mul_f32 v96, v96, v100
    v_mul_f32 v97, v97, v101
    v_mul_f32 v98, v98, v102
    v_mfma_f32_16x16x32_bf16 v[112:115], a[16:19], v[144:147], v[112:115]
    v_mul_f32 v99, v99, v103
    v_mul_f32 v104, v104, v108
    v_mul_f32 v105, v105, v109
    v_mul_f32 v106, v106, v110
    v_mfma_f32_16x16x32_bf16 v[116:119], a[20:23], v[144:147], v[116:119]
    ds_read_b128 v[144:147], v201 offset:28672
    v_mul_f32 v107, v107, v111
    v_cvt_pk_bf16_f32 v100, v96, v97
    v_cvt_pk_bf16_f32 v101, v98, v99
    v_mfma_f32_16x16x32_bf16 v[120:123], a[16:19], v[148:151], v[120:123]
    buffer_load_dwordx4 a[232:235], v11, s[32:35], s7 offen sc1
    v_cvt_pk_bf16_f32 v102, v104, v105
    v_cvt_pk_bf16_f32 v103, v106, v107
    v_mfma_f32_16x16x32_bf16 v[124:127], a[20:23], v[148:151], v[124:127]
    ds_read_b128 v[148:151], v200 offset:10240
    s_mov_b32 s18, 552960
    v_mfma_f32_16x16x32_bf16 v[112:115], a[24:27], v[152:155], v[112:115]
    v_permlane16_swap_b32 v100, v102
    v_permlane16_swap_b32 v101, v103
    v_mfma_f32_16x16x32_bf16 v[116:119], a[28:31], v[152:155], v[116:119]
    ds_read_b128 v[152:155], v200 offset:30720
    buffer_store_dwordx4 v[100:103], v204, s[28:31], s18 offen sc1
    v_mfma_f32_16x16x32_bf16 v[120:123], a[24:27], v[156:159], v[120:123]
    buffer_load_dwordx4 a[236:239], v12, s[32:35], s7 offen sc1
    v_mfma_f32_16x16x32_bf16 v[124:127], a[28:31], v[156:159], v[124:127]
    ds_read_b128 v[156:159], v201 offset:10240
    s_waitcnt lgkmcnt(3)
    v_mfma_f32_16x16x32_bf16 v[112:115], a[32:35], v[160:163], v[112:115]
    v_mfma_f32_16x16x32_bf16 v[116:119], a[36:39], v[160:163], v[116:119]
    ds_read_b128 v[160:163], v201 offset:30720
    v_mfma_f32_16x16x32_bf16 v[120:123], a[32:35], v[164:167], v[120:123]
    buffer_load_dwordx4 a[240:243], v8, s[32:35], s8 offen sc1
    v_mfma_f32_16x16x32_bf16 v[124:127], a[36:39], v[164:167], v[124:127]
    ds_read_b128 v[164:167], v200 offset:12288
    v_mfma_f32_16x16x32_bf16 v[112:115], a[40:43], v[168:171], v[112:115]
    v_mfma_f32_16x16x32_bf16 v[116:119], a[44:47], v[168:171], v[116:119]
    ds_read_b128 v[168:171], v200 offset:32768
    v_mfma_f32_16x16x32_bf16 v[120:123], a[40:43], v[172:175], v[120:123]
    buffer_load_dwordx4 a[244:247], v9, s[32:35], s8 offen sc1
    v_mfma_f32_16x16x32_bf16 v[124:127], a[44:47], v[172:175], v[124:127]
    ds_read_b128 v[172:175], v201 offset:12288
    v_mfma_f32_16x16x32_bf16 v[112:115], a[48:51], v[176:179], v[112:115]
    v_mfma_f32_16x16x32_bf16 v[116:119], a[52:55], v[176:179], v[116:119]
    ds_read_b128 v[176:179], v201 offset:32768
    v_mfma_f32_16x16x32_bf16 v[120:123], a[48:51], v[180:183], v[120:123]
    buffer_load_dwordx4 a[248:251], v10, s[32:35], s8 offen sc1
    v_mfma_f32_16x16x32_bf16 v[124:127], a[52:55], v[180:183], v[124:127]
    ds_read_b128 v[180:183], v200 offset:14336
    v_mfma_f32_16x16x32_bf16 v[112:115], a[56:59], v[184:187], v[112:115]
    v_mfma_f32_16x16x32_bf16 v[116:119], a[60:63], v[184:187], v[116:119]
    ds_read_b128 v[184:187], v200 offset:34816
    v_mfma_f32_16x16x32_bf16 v[120:123], a[56:59], v[128:131], v[120:123]
    buffer_load_dwordx4 a[252:255], v11, s[32:35], s8 offen sc1
    v_mfma_f32_16x16x32_bf16 v[124:127], a[60:63], v[128:131], v[124:127]
    ds_read_b128 v[128:131], v201 offset:14336
    v_mfma_f32_16x16x32_bf16 v[112:115], a[64:67], v[132:135], v[112:115]
    v_mfma_f32_16x16x32_bf16 v[116:119], a[68:71], v[132:135], v[116:119]
    ds_read_b128 v[132:135], v201 offset:34816
    v_mfma_f32_16x16x32_bf16 v[120:123], a[64:67], v[136:139], v[120:123]
    buffer_load_dwordx4 v[212:215], v12, s[32:35], s8 offen sc1
    v_mfma_f32_16x16x32_bf16 v[124:127], a[68:71], v[136:139], v[124:127]
    ds_read_b128 v[136:139], v200 offset:16384
    v_mfma_f32_16x16x32_bf16 v[112:115], a[72:75], v[140:143], v[112:115]
    v_mfma_f32_16x16x32_bf16 v[116:119], a[76:79], v[140:143], v[116:119]
    ds_read_b128 v[140:143], v200 offset:36864
    v_mfma_f32_16x16x32_bf16 v[120:123], a[72:75], v[144:147], v[120:123]
    buffer_load_dwordx4 v[216:219], v8, s[32:35], s9 offen sc1
    v_mfma_f32_16x16x32_bf16 v[124:127], a[76:79], v[144:147], v[124:127]
    ds_read_b128 v[144:147], v201 offset:16384
    s_waitcnt lgkmcnt(3)
    v_mfma_f32_16x16x32_bf16 v[112:115], a[80:83], v[148:151], v[112:115]
    v_mfma_f32_16x16x32_bf16 v[116:119], a[84:87], v[148:151], v[116:119]
    ds_read_b128 v[148:151], v201 offset:36864
    v_mfma_f32_16x16x32_bf16 v[120:123], a[80:83], v[152:155], v[120:123]
    buffer_load_dwordx4 v[220:223], v9, s[32:35], s9 offen sc1
    v_mfma_f32_16x16x32_bf16 v[124:127], a[84:87], v[152:155], v[124:127]
    ds_read_b128 v[152:155], v200 offset:18432
    v_mfma_f32_16x16x32_bf16 v[112:115], a[88:91], v[156:159], v[112:115]
    v_mfma_f32_16x16x32_bf16 v[116:119], a[92:95], v[156:159], v[116:119]
    ds_read_b128 v[156:159], v200 offset:38912
    v_mfma_f32_16x16x32_bf16 v[120:123], a[88:91], v[160:163], v[120:123]
    buffer_load_dwordx4 v[224:227], v10, s[32:35], s9 offen sc1
    v_mfma_f32_16x16x32_bf16 v[124:127], a[92:95], v[160:163], v[124:127]
    ds_read_b128 v[160:163], v201 offset:18432
    v_mfma_f32_16x16x32_bf16 v[112:115], a[96:99], v[164:167], v[112:115]
    v_mfma_f32_16x16x32_bf16 v[116:119], a[100:103], v[164:167], v[116:119]
    s_waitcnt vmcnt(34)
    s_barrier
    v_mfma_f32_16x16x32_bf16 v[120:123], a[96:99], v[168:171], v[120:123]
    ds_read_b128 v[164:167], v201 offset:38912
    v_mfma_f32_16x16x32_bf16 v[124:127], a[100:103], v[168:171], v[124:127]
    ds_read_b128 v[168:171], v198 offset:0
    v_mfma_f32_16x16x32_bf16 v[112:115], a[104:107], v[172:175], v[112:115]
    buffer_load_dwordx4 v[228:231], v11, s[32:35], s9 offen sc1
    v_mfma_f32_16x16x32_bf16 v[116:119], a[108:111], v[172:175], v[116:119]
    ds_read_b128 v[172:175], v198 offset:20480
    v_mfma_f32_16x16x32_bf16 v[120:123], a[104:107], v[176:179], v[120:123]
    v_mfma_f32_16x16x32_bf16 v[124:127], a[108:111], v[176:179], v[124:127]
    ds_read_b128 v[176:179], v199 offset:0
    v_mfma_f32_16x16x32_bf16 v[112:115], a[112:115], v[180:183], v[112:115]
    buffer_load_dwordx4 v[232:235], v12, s[32:35], s9 offen sc1
    v_mfma_f32_16x16x32_bf16 v[116:119], a[116:119], v[180:183], v[116:119]
    ds_read_b128 v[180:183], v199 offset:20480
    v_mfma_f32_16x16x32_bf16 v[120:123], a[112:115], v[184:187], v[120:123]
    v_mfma_f32_16x16x32_bf16 v[124:127], a[116:119], v[184:187], v[124:127]
    ds_read_b128 v[184:187], v198 offset:2048
    v_mfma_f32_16x16x32_bf16 v[112:115], a[120:123], v[128:131], v[112:115]
    buffer_load_dwordx4 v[236:239], v8, s[32:35], s10 offen sc1
    v_mfma_f32_16x16x32_bf16 v[116:119], a[124:127], v[128:131], v[116:119]
    ds_read_b128 v[128:131], v198 offset:22528
    v_mfma_f32_16x16x32_bf16 v[120:123], a[120:123], v[132:135], v[120:123]
    v_mfma_f32_16x16x32_bf16 v[124:127], a[124:127], v[132:135], v[124:127]
    ds_read_b128 v[132:135], v199 offset:2048
    s_waitcnt lgkmcnt(3)
    v_mfma_f32_16x16x32_bf16 v[112:115], a[128:131], v[136:139], v[112:115]
    buffer_load_dwordx4 v[240:243], v9, s[32:35], s10 offen sc1
    v_mfma_f32_16x16x32_bf16 v[116:119], a[132:135], v[136:139], v[116:119]
    ds_read_b128 v[136:139], v199 offset:22528
    v_mfma_f32_16x16x32_bf16 v[120:123], a[128:131], v[140:143], v[120:123]
    v_mfma_f32_16x16x32_bf16 v[124:127], a[132:135], v[140:143], v[124:127]
    ds_read_b128 v[140:143], v198 offset:4096
    v_mfma_f32_16x16x32_bf16 v[112:115], a[136:139], v[144:147], v[112:115]
    buffer_load_dwordx4 v[244:247], v10, s[32:35], s10 offen sc1
    v_mfma_f32_16x16x32_bf16 v[116:119], a[140:143], v[144:147], v[116:119]
    ds_read_b128 v[144:147], v198 offset:24576
    v_mfma_f32_16x16x32_bf16 v[120:123], a[136:139], v[148:151], v[120:123]
    v_mfma_f32_16x16x32_bf16 v[124:127], a[140:143], v[148:151], v[124:127]
    ds_read_b128 v[148:151], v199 offset:4096
    v_mfma_f32_16x16x32_bf16 v[112:115], a[144:147], v[152:155], v[112:115]
    buffer_load_dwordx4 v[248:251], v11, s[32:35], s10 offen sc1
    v_mfma_f32_16x16x32_bf16 v[116:119], a[148:151], v[152:155], v[116:119]
    ds_read_b128 v[152:155], v199 offset:24576
    v_mfma_f32_16x16x32_bf16 v[120:123], a[144:147], v[156:159], v[120:123]
    v_mfma_f32_16x16x32_bf16 v[124:127], a[148:151], v[156:159], v[124:127]
    ds_read_b128 v[156:159], v198 offset:6144
    v_mfma_f32_16x16x32_bf16 v[112:115], a[152:155], v[160:163], v[112:115]
    buffer_load_dwordx4 v[252:255], v12, s[32:35], s10 offen sc1
    v_mfma_f32_16x16x32_bf16 v[116:119], a[156:159], v[160:163], v[116:119]
    ds_read_b128 v[160:163], v198 offset:26624
    v_mfma_f32_16x16x32_bf16 v[120:123], a[152:155], v[164:167], v[120:123]
    v_mfma_f32_16x16x32_bf16 v[124:127], a[156:159], v[164:167], v[124:127]
    s_waitcnt vmcnt(16)
    s_barrier
    s_cmp_lg_u32 s56, 0
    s_cbranch_scc1 L_nofl1
    s_atomic_swap s59, s[40:41], 0
L_nofl1:
    v_mfma_f32_16x16x32_bf16 v[16:19], a[0:3], v[168:171], 0
    ds_read_b128 v[164:167], v199 offset:6144
    v_mfma_f32_16x16x32_bf16 v[20:23], a[4:7], v[168:171], 0
    ds_read_b128 v[168:171], v199 offset:26624
    v_mfma_f32_16x16x32_bf16 v[24:27], a[0:3], v[172:175], 0
    buffer_load_dwordx4 v[32:35], v8, s[32:35], s11 offen sc1
    v_mfma_f32_16x16x32_bf16 v[28:31], a[4:7], v[172:175], 0
    ds_read_b128 v[172:175], v198 offset:8192
    v_mfma_f32_16x16x32_bf16 v[16:19], a[8:11], v[176:179], v[16:19]
    v_mfma_f32_16x16x32_bf16 v[20:23], a[12:15], v[176:179], v[20:23]
    ds_read_b128 v[176:179], v198 offset:28672
    v_mfma_f32_16x16x32_bf16 v[24:27], a[8:11], v[180:183], v[24:27]
    buffer_load_dwordx4 v[40:43], v9, s[32:35], s11 offen sc1
    v_mfma_f32_16x16x32_bf16 v[28:31], a[12:15], v[180:183], v[28:31]
    ds_read_b128 v[180:183], v199 offset:8192
    v_mul_f32 v112, v112, v116
    s_waitcnt lgkmcnt(3)
    v_mfma_f32_16x16x32_bf16 v[16:19], a[16:19], v[184:187], v[16:19]
    v_mul_f32 v113, v113, v117
    v_mul_f32 v114, v114, v118
    v_mfma_f32_16x16x32_bf16 v[20:23], a[20:23], v[184:187], v[20:23]
    ds_read_b128 v[184:187], v199 offset:28672
    v_mul_f32 v115, v115, v119
    v_mfma_f32_16x16x32_bf16 v[24:27], a[16:19], v[128:131], v[24:27]
    v_mul_f32 v120, v120, v124
    v_mul_f32 v121, v121, v125
    v_mfma_f32_16x16x32_bf16 v[28:31], a[20:23], v[128:131], v[28:31]
    ds_read_b128 v[128:131], v198 offset:10240
    v_mul_f32 v122, v122, v126
    v_mfma_f32_16x16x32_bf16 v[16:19], a[24:27], v[132:135], v[16:19]
    v_mul_f32 v123, v123, v127
    v_cvt_pk_bf16_f32 v116, v112, v113
    v_mfma_f32_16x16x32_bf16 v[20:23], a[28:31], v[132:135], v[20:23]
    ds_read_b128 v[132:135], v198 offset:30720
    v_cvt_pk_bf16_f32 v117, v114, v115
    v_mfma_f32_16x16x32_bf16 v[24:27], a[24:27], v[136:139], v[24:27]
    v_cvt_pk_bf16_f32 v118, v120, v121
    v_cvt_pk_bf16_f32 v119, v122, v123
    v_mfma_f32_16x16x32_bf16 v[28:31], a[28:31], v[136:139], v[28:31]
    ds_read_b128 v[136:139], v199 offset:10240
    s_mov_b32 s18, s0
    v_mfma_f32_16x16x32_bf16 v[16:19], a[32:35], v[140:143], v[16:19]
    v_permlane16_swap_b32 v116, v118
    v_mfma_f32_16x16x32_bf16 v[20:23], a[36:39], v[140:143], v[20:23]
    ds_read_b128 v[140:143], v199 offset:30720
    v_mfma_f32_16x16x32_bf16 v[24:27], a[32:35], v[144:147], v[24:27]
    v_permlane16_swap_b32 v117, v119
    v_mfma_f32_16x16x32_bf16 v[28:31], a[36:39], v[144:147], v[28:31]
    ds_read_b128 v[144:147], v198 offset:12288
    v_mfma_f32_16x16x32_bf16 v[16:19], a[40:43], v[148:151], v[16:19]
    buffer_store_dwordx4 v[116:119], v204, s[28:31], s18 offen sc1
    v_mfma_f32_16x16x32_bf16 v[20:23], a[44:47], v[148:151], v[20:23]
    ds_read_b128 v[148:151], v198 offset:32768
    v_mfma_f32_16x16x32_bf16 v[24:27], a[40:43], v[152:155], v[24:27]
    buffer_load_dwordx4 v[44:47], v10, s[32:35], s11 offen sc1
    v_mfma_f32_16x16x32_bf16 v[28:31], a[44:47], v[152:155], v[28:31]
    ds_read_b128 v[152:155], v199 offset:12288
    v_mfma_f32_16x16x32_bf16 v[16:19], a[48:51], v[156:159], v[16:19]
    v_mfma_f32_16x16x32_bf16 v[20:23], a[52:55], v[156:159], v[20:23]
    ds_read_b128 v[156:159], v199 offset:32768
    v_mfma_f32_16x16x32_bf16 v[24:27], a[48:51], v[160:163], v[24:27]
    buffer_load_dwordx4 v[48:51], v11, s[32:35], s11 offen sc1
    v_mfma_f32_16x16x32_bf16 v[28:31], a[52:55], v[160:163], v[28:31]
    ds_read_b128 v[160:163], v198 offset:14336
    v_mfma_f32_16x16x32_bf16 v[16:19], a[56:59], v[164:167], v[16:19]
    v_mfma_f32_16x16x32_bf16 v[20:23], a[60:63], v[164:167], v[20:23]
    ds_read_b128 v[164:167], v198 offset:34816
    v_mfma_f32_16x16x32_bf16 v[24:27], a[56:59], v[168:171], v[24:27]
    buffer_load_dwordx4 v[56:59], v12, s[32:35], s11 offen sc1
    v_mfma_f32_16x16x32_bf16 v[28:31], a[60:63], v[168:171], v[28:31]
    ds_read_b128 v[168:171], v199 offset:14336
    s_waitcnt lgkmcnt(3)
    v_mfma_f32_16x16x32_bf16 v[16:19], a[64:67], v[172:175], v[16:19]
    v_mfma_f32_16x16x32_bf16 v[20:23], a[68:71], v[172:175], v[20:23]
    ds_read_b128 v[172:175], v199 offset:34816
    v_mfma_f32_16x16x32_bf16 v[24:27], a[64:67], v[176:179], v[24:27]
    buffer_load_dwordx4 v[60:63], v8, s[32:35], s12 offen sc1
    v_mfma_f32_16x16x32_bf16 v[28:31], a[68:71], v[176:179], v[28:31]
    ds_read_b128 v[176:179], v198 offset:16384
    v_mfma_f32_16x16x32_bf16 v[16:19], a[72:75], v[180:183], v[16:19]
    v_mfma_f32_16x16x32_bf16 v[20:23], a[76:79], v[180:183], v[20:23]
    ds_read_b128 v[180:183], v198 offset:36864
    v_mfma_f32_16x16x32_bf16 v[24:27], a[72:75], v[184:187], v[24:27]
    buffer_load_dwordx4 v[64:67], v9, s[32:35], s12 offen sc1
    v_mfma_f32_16x16x32_bf16 v[28:31], a[76:79], v[184:187], v[28:31]
    ds_read_b128 v[184:187], v199 offset:16384
    v_mfma_f32_16x16x32_bf16 v[16:19], a[80:83], v[128:131], v[16:19]
    v_mfma_f32_16x16x32_bf16 v[20:23], a[84:87], v[128:131], v[20:23]
    ds_read_b128 v[128:131], v199 offset:36864
    v_mfma_f32_16x16x32_bf16 v[24:27], a[80:83], v[132:135], v[24:27]
    buffer_load_dwordx4 v[72:75], v10, s[32:35], s12 offen sc1
    v_mfma_f32_16x16x32_bf16 v[28:31], a[84:87], v[132:135], v[28:31]
    ds_read_b128 v[132:135], v198 offset:18432
    v_mfma_f32_16x16x32_bf16 v[16:19], a[88:91], v[136:139], v[16:19]
    v_mfma_f32_16x16x32_bf16 v[20:23], a[92:95], v[136:139], v[20:23]
    ds_read_b128 v[136:139], v198 offset:38912
    v_mfma_f32_16x16x32_bf16 v[24:27], a[88:91], v[140:143], v[24:27]
    buffer_load_dwordx4 v[76:79], v11, s[32:35], s12 offen sc1
    v_mfma_f32_16x16x32_bf16 v[28:31], a[92:95], v[140:143], v[28:31]
    ds_read_b128 v[140:143], v199 offset:18432
    v_mfma_f32_16x16x32_bf16 v[16:19], a[96:99], v[144:147], v[16:19]
    v_mfma_f32_16x16x32_bf16 v[20:23], a[100:103], v[144:147], v[20:23]
    ds_read_b128 v[144:147], v199 offset:38912
L_pad2:
    s_cbranch_execz L_padret
    v_mfma_f32_16x16x32_bf16 v[24:27], a[96:99], v[148:151], v[24:27]
    buffer_load_dwordx4 v[80:83], v12, s[32:35], s12 offen sc1
    v_mfma_f32_16x16x32_bf16 v[28:31], a[100:103], v[148:151], v[28:31]
    v_mfma_f32_16x16x32_bf16 v[16:19], a[104:107], v[152:155], v[16:19]
    v_mfma_f32_16x16x32_bf16 v[20:23], a[108:111], v[152:155], v[20:23]
    v_mfma_f32_16x16x32_bf16 v[24:27], a[104:107], v[156:159], v[24:27]
    buffer_load_dwordx4 v[88:91], v8, s[32:35], s13 offen sc1
    v_mfma_f32_16x16x32_bf16 v[28:31], a[108:111], v[156:159], v[28:31]
    s_waitcnt lgkmcnt(3)
    v_mfma_f32_16x16x32_bf16 v[16:19], a[112:115], v[160:163], v[16:19]
    v_mfma_f32_16x16x32_bf16 v[20:23], a[116:119], v[160:163], v[20:23]
    v_mfma_f32_16x16x32_bf16 v[24:27], a[112:115], v[164:167], v[24:27]
    buffer_load_dwordx4 v[92:95], v9, s[32:35], s13 offen sc1
    v_mfma_f32_16x16x32_bf16 v[28:31], a[116:119], v[164:167], v[28:31]
    v_mfma_f32_16x16x32_bf16 v[16:19], a[120:123], v[168:171], v[16:19]
    v_mfma_f32_16x16x32_bf16 v[20:23], a[124:127], v[168:171], v[20:23]
    v_mfma_f32_16x16x32_bf16 v[24:27], a[120:123], v[172:175], v[24:27]
    buffer_load_dwordx4 v[96:99], v10, s[32:35], s13 offen sc1
    v_mfma_f32_16x16x32_bf16 v[28:31], a[124:127], v[172:175], v[28:31]
    v_mfma_f32_16x16x32_bf16 v[16:19], a[128:131], v[176:179], v[16:19]
    v_mfma_f32_16x16x32_bf16 v[20:23], a[132:135], v[176:179], v[20:23]
    v_mfma_f32_16x16x32_bf16 v[24:27], a[128:131], v[180:183], v[24:27]
    buffer_load_dwordx4 v[104:107], v11, s[32:35], s13 offen sc1
    v_mfma_f32_16x16x32_bf16 v[28:31], a[132:135], v[180:183], v[28:31]
    v_mfma_f32_16x16x32_bf16 v[16:19], a[136:139], v[184:187], v[16:19]
    v_mfma_f32_16x16x32_bf16 v[20:23], a[140:143], v[184:187], v[20:23]
    v_mfma_f32_16x16x32_bf16 v[24:27], a[136:139], v[128:131], v[24:27]
    buffer_load_dwordx4 v[108:111], v12, s[32:35], s13 offen sc1
    v_mfma_f32_16x16x32_bf16 v[28:31], a[140:143], v[128:131], v[28:31]
    v_mfma_f32_16x16x32_bf16 v[16:19], a[144:147], v[132:135], v[16:19]
    v_mfma_f32_16x16x32_bf16 v[20:23], a[148:151], v[132:135], v[20:23]
    s_waitcnt lgkmcnt(2)
    v_mfma_f32_16x16x32_bf16 v[24:27], a[144:147], v[136:139], v[24:27]
    buffer_load_dwordx4 v[36:39], v8, s[32:35], s14 offen sc1
    v_mfma_f32_16x16x32_bf16 v[28:31], a[148:151], v[136:139], v[28:31]
    s_waitcnt lgkmcnt(1)
    v_mfma_f32_16x16x32_bf16 v[16:19], a[152:155], v[140:143], v[16:19]
    v_mfma_f32_16x16x32_bf16 v[20:23], a[156:159], v[140:143], v[20:23]
    s_waitcnt lgkmcnt(0)
    v_mfma_f32_16x16x32_bf16 v[24:27], a[152:155], v[144:147], v[24:27]
    buffer_load_dwordx4 v[52:55], v9, s[32:35], s14 offen sc1
    v_mfma_f32_16x16x32_bf16 v[28:31], a[156:159], v[144:147], v[28:31]
    s_nop 7
    v_mul_f32 v16, v16, v20
    v_mul_f32 v17, v17, v21
    v_mul_f32 v18, v18, v22
    v_mul_f32 v19, v19, v23
    v_mul_f32 v24, v24, v28
    v_mul_f32 v25, v25, v29
    v_mul_f32 v26, v26, v30
    v_mul_f32 v27, v27, v31
    v_cvt_pk_bf16_f32 v20, v16, v17
    v_cvt_pk_bf16_f32 v21, v18, v19
    v_cvt_pk_bf16_f32 v22, v24, v25
    v_cvt_pk_bf16_f32 v23, v26, v27
    s_mov_b32 s18, s1
    s_nop 0
    v_permlane16_swap_b32 v20, v22
    v_permlane16_swap_b32 v21, v23
    buffer_store_dwordx4 v[20:23], v204, s[28:31], s18 offen sc1
    buffer_load_dwordx4 v[68:71], v10, s[32:35], s14 offen sc1
    buffer_load_dwordx4 v[84:87], v11, s[32:35], s14 offen sc1
    buffer_load_dwordx4 v[100:103], v12, s[32:35], s14 offen sc1
    buffer_load_dwordx4 v[112:115], v8, s[32:35], s15 offen sc1
    s_lshr_b32 s60, s76, 2
    s_and_b32 s61, s76, 3
    s_lshl4_add_u32 s62, s60, s61
    s_mul_i32 s60, s60, 864
    s_mul_i32 s61, s61, 54
    s_add_u32 s60, s60, s61
    s_mul_i32 s61, s56, 14
    s_add_u32 s60, s60, s61
    s_lshl_b32 s60, s60, 10
    v_lshl_add_u32 v4, v1, 4, s60
    v_add_u32 v5, 221184, v4
    v_add_u32 v6, 442368, v4
    v_add_u32 v7, 663552, v4
    v_and_b32 v2, 3, v1
    v_mul_u32_u24 v2, 26, v2
    v_bfe_u32 v3, v1, 2, 2
    v_mul_u32_u24 v3, 105, v3
    v_bfe_u32 v29, v1, 4, 1
    v_mul_u32_u24 v29, 10, v29
    v_add3_u32 v2, v2, v3, v29
    v_lshrrev_b32 v3, 5, v1
    s_mul_i32 s60, s56, 420
    v_add3_u32 v2, v2, v3, s60
    v_lshlrev_b32 v29, 4, v2
    v_min_u32 v2, 39, v1
    v_mul_u32_u24 v3, 26, v2
    v_lshrrev_b32 v3, 8, v3
    v_lshl_add_u32 v28, v3, 4, v2
    s_mul_i32 s60, s56, 105
    v_add_lshl_u32 v28, v28, s60, 4
    v_mul_u32_u24 v30, 10, v3
    v_sub_u32 v2, v2, v30
    s_lshl_b32 s60, s56, 2
    v_add_u32 v3, s60, v3
    v_add_u32 v26, 53760, v28
    v_add_u32 v27, 53760, v29
    s_lshl_b32 s62, s62, 4
    v_add_u32 v3, s62, v3
    v_mul_u32_u24 v3, 1280, v3
    v_lshl_add_u32 v3, v2, 4, v3
    s_mul_i32 s60, s77, 160
    v_add_u32 v3, s60, v3
    v_cmp_gt_u32 vcc, 40, v1
    v_mov_b32 v2, 2147483648
    s_nop 0
    v_cndmask_b32 v30, v2, v3, vcc
    buffer_load_dwordx4 v[120:123], v9, s[32:35], s15 offen sc1
    buffer_load_dwordx4 v[124:127], v10, s[32:35], s15 offen sc1
    buffer_load_dwordx4 v[116:119], v11, s[32:35], s15 offen sc1
    buffer_load_dwordx4 v[128:131], v12, s[32:35], s15 offen sc1
    s_load_dword s60, s[42:43], 0
    s_load_dword s61, s[42:43], 256
    s_load_dword s62, s[42:43], 512
    s_load_dword s63, s[42:43], 768
    s_load_dword s64, s[42:43], 1024
    s_load_dword s65, s[42:43], 1280
    s_load_dword s66, s[42:43], 1536
    buffer_load_dwordx4 v[132:135], v8, s[32:35], s16 offen sc1
    buffer_load_dwordx4 v[136:139], v9, s[32:35], s16 offen sc1
    buffer_load_dwordx4 v[140:143], v10, s[32:35], s16 offen sc1
    buffer_load_dwordx4 v[144:147], v11, s[32:35], s16 offen sc1
    buffer_load_dwordx4 v[148:151], v12, s[32:35], s16 offen sc1
    buffer_load_dwordx4 v[152:155], v8, s[32:35], s17 offen sc1
    buffer_load_dwordx4 v[156:159], v9, s[32:35], s17 offen sc1
    buffer_load_dwordx4 v[160:163], v10, s[32:35], s17 offen sc1
    s_waitcnt lgkmcnt(0)
    s_cmp_eq_u32 s56, 3
    s_cselect_b32 s66, s59, s66
    s_xor_b32 s60, s60, s59
    s_xor_b32 s61, s61, s59
    s_xor_b32 s62, s62, s59
    s_xor_b32 s63, s63, s59
    s_xor_b32 s64, s64, s59
    s_xor_b32 s65, s65, s59
    s_xor_b32 s66, s66, s59
    s_or_b32 s60, s60, s61
    s_or_b32 s60, s60, s62
    s_or_b32 s60, s60, s63
    s_or_b32 s60, s60, s64
    s_or_b32 s60, s60, s65
    s_or_b32 s60, s60, s66
    s_cbranch_scc1 L_hslow
L_hgo:
    buffer_load_dwordx4 a[80:83], v4, s[28:31], s4 offen sc1
    buffer_load_dwordx4 a[84:87], v4, s[28:31], s5 offen sc1
    s_waitcnt vmcnt(18)
    s_barrier
    s_cmp_lg_u32 s56, 0
    s_cbranch_scc1 L_nofl2
    s_atomic_swap s59, s[40:41], 128
L_nofl2:
    buffer_load_dwordx4 a[88:91], v4, s[28:31], s6 offen sc1
    buffer_load_dwordx4 a[92:95], v4, s[28:31], s7 offen sc1
    buffer_load_dwordx4 a[96:99], v4, s[28:31], s8 offen sc1
    buffer_load_dwordx4 a[100:103], v4, s[28:31], s9 offen sc1
    buffer_load_dwordx4 a[104:107], v4, s[28:31], s10 offen sc1
    buffer_load_dwordx4 v[164:167], v11, s[32:35], s17 offen sc1
    buffer_load_dwordx4 a[108:111], v4, s[28:31], s11 offen sc1
    buffer_load_dwordx4 a[112:115], v4, s[28:31], s12 offen sc1
    s_waitcnt vmcnt(9)
    v_mfma_f32_16x16x32_bf16 a[0:3], a[160:163], a[80:83], 0
    buffer_load_dwordx4 a[116:119], v4, s[28:31], s13 offen sc1
    v_mfma_f32_16x16x32_bf16 a[4:7], a[164:167], a[80:83], 0
    v_mfma_f32_16x16x32_bf16 a[8:11], a[168:171], a[80:83], 0
    v_mfma_f32_16x16x32_bf16 a[12:15], a[172:175], a[80:83], 0
    v_mfma_f32_16x16x32_bf16 a[16:19], a[176:179], a[80:83], 0
    s_waitcnt vmcnt(9)
    v_mfma_f32_16x16x32_bf16 a[0:3], a[180:183], a[84:87], a[0:3]
    v_mfma_f32_16x16x32_bf16 a[4:7], a[184:187], a[84:87], a[4:7]
    buffer_load_dwordx4 a[120:123], v4, s[28:31], s14 offen sc1
    v_mfma_f32_16x16x32_bf16 a[8:11], a[188:191], a[84:87], a[8:11]
    v_mfma_f32_16x16x32_bf16 a[12:15], a[192:195], a[84:87], a[12:15]
    v_mfma_f32_16x16x32_bf16 a[16:19], a[196:199], a[84:87], a[16:19]
    s_waitcnt vmcnt(9)
    v_mfma_f32_16x16x32_bf16 a[0:3], a[200:203], a[88:91], a[0:3]
    v_mfma_f32_16x16x32_bf16 a[4:7], a[204:207], a[88:91], a[4:7]
    buffer_load_dwordx4 a[124:127], v4, s[28:31], s15 offen sc1
    v_mfma_f32_16x16x32_bf16 a[8:11], a[208:211], a[88:91], a[8:11]
    v_mfma_f32_16x16x32_bf16 a[12:15], a[212:215], a[88:91], a[12:15]
    v_mfma_f32_16x16x32_bf16 a[16:19], a[216:219], a[88:91], a[16:19]
    s_waitcnt vmcnt(9)
    v_mfma_f32_16x16x32_bf16 a[0:3], a[220:223], a[92:95], a[0:3]
    v_mfma_f32_16x16x32_bf16 a[4:7], a[224:227], a[92:95], a[4:7]
    buffer_load_dwordx4 a[128:131], v4, s[28:31], s16 offen sc1
    v_mfma_f32_16x16x32_bf16 a[8:11], a[228:231], a[92:95], a[8:11]
    v_mfma_f32_16x16x32_bf16 a[12:15], a[232:235], a[92:95], a[12:15]
    v_mfma_f32_16x16x32_bf16 a[16:19], a[236:239], a[92:95], a[16:19]
    s_waitcnt vmcnt(9)
    v_mfma_f32_16x16x32_bf16 a[0:3], a[240:243], a[96:99], a[0:3]
    v_mfma_f32_16x16x32_bf16 a[4:7], a[244:247], a[96:99], a[4:7]
    buffer_load_dwordx4 v[168:171], v12, s[32:35], s17 offen sc1
    v_mfma_f32_16x16x32_bf16 a[8:11], a[248:251], a[96:99], a[8:11]
    v_mfma_f32_16x16x32_bf16 a[12:15], a[252:255], a[96:99], a[12:15]
    v_mfma_f32_16x16x32_bf16 a[16:19], v[212:215], a[96:99], a[16:19]
    s_waitcnt vmcnt(9)
    v_mfma_f32_16x16x32_bf16 a[0:3], v[216:219], a[100:103], a[0:3]
    v_mfma_f32_16x16x32_bf16 a[4:7], v[220:223], a[100:103], a[4:7]
    buffer_load_dwordx4 a[132:135], v4, s[28:31], s17 offen sc1
    v_mfma_f32_16x16x32_bf16 a[8:11], v[224:227], a[100:103], a[8:11]
    v_mfma_f32_16x16x32_bf16 a[12:15], v[228:231], a[100:103], a[12:15]
    v_mfma_f32_16x16x32_bf16 a[16:19], v[232:235], a[100:103], a[16:19]
    s_waitcnt vmcnt(9)
    v_mfma_f32_16x16x32_bf16 a[0:3], v[236:239], a[104:107], a[0:3]
    v_mfma_f32_16x16x32_bf16 a[4:7], v[240:243], a[104:107], a[4:7]
    buffer_load_dwordx4 a[136:139], v5, s[28:31], s4 offen sc1
    v_mfma_f32_16x16x32_bf16 a[8:11], v[244:247], a[104:107], a[8:11]
    v_mfma_f32_16x16x32_bf16 a[12:15], v[248:251], a[104:107], a[12:15]
    buffer_load_dwordx4 a[140:143], v5, s[28:31], s5 offen sc1
    v_mfma_f32_16x16x32_bf16 a[16:19], v[252:255], a[104:107], a[16:19]
    s_waitcnt vmcnt(9)
    v_mfma_f32_16x16x32_bf16 a[0:3], v[32:35], a[108:111], a[0:3]
    v_mfma_f32_16x16x32_bf16 a[4:7], v[40:43], a[108:111], a[4:7]
    buffer_load_dwordx4 a[144:147], v5, s[28:31], s6 offen sc1
    v_mfma_f32_16x16x32_bf16 a[8:11], v[44:47], a[108:111], a[8:11]
    v_mfma_f32_16x16x32_bf16 a[12:15], v[48:51], a[108:111], a[12:15]
    v_mfma_f32_16x16x32_bf16 a[16:19], v[56:59], a[108:111], a[16:19]
    s_waitcnt vmcnt(9)
    v_mfma_f32_16x16x32_bf16 a[0:3], v[60:63], a[112:115], a[0:3]
    v_mfma_f32_16x16x32_bf16 a[4:7], v[64:67], a[112:115], a[4:7]
    buffer_load_dwordx4 a[148:151], v5, s[28:31], s7 offen sc1
    v_mfma_f32_16x16x32_bf16 a[8:11], v[72:75], a[112:115], a[8:11]
    v_mfma_f32_16x16x32_bf16 a[12:15], v[76:79], a[112:115], a[12:15]
    v_mfma_f32_16x16x32_bf16 a[16:19], v[80:83], a[112:115], a[16:19]
    s_waitcnt vmcnt(9)
    v_mfma_f32_16x16x32_bf16 a[0:3], v[88:91], a[116:119], a[0:3]
    v_mfma_f32_16x16x32_bf16 a[4:7], v[92:95], a[116:119], a[4:7]
    buffer_load_dwordx4 a[152:155], v5, s[28:31], s8 offen sc1
    v_mfma_f32_16x16x32_bf16 a[8:11], v[96:99], a[116:119], a[8:11]
    v_mfma_f32_16x16x32_bf16 a[12:15], v[104:107], a[116:119], a[12:15]
    v_mfma_f32_16x16x32_bf16 a[16:19], v[108:111], a[116:119], a[16:19]
    s_waitcnt vmcnt(9)
    v_mfma_f32_16x16x32_bf16 a[0:3], v[36:39], a[120:123], a[0:3]
    v_mfma_f32_16x16x32_bf16 a[4:7], v[52:55], a[120:123], a[4:7]
    buffer_load_dwordx4 a[156:159], v5, s[28:31], s9 offen sc1
    v_mfma_f32_16x16x32_bf16 a[8:11], v[68:71], a[120:123], a[8:11]
    v_mfma_f32_16x16x32_bf16 a[12:15], v[84:87], a[120:123], a[12:15]
    v_mfma_f32_16x16x32_bf16 a[16:19], v[100:103], a[120:123], a[16:19]
    s_waitcnt vmcnt(9)
    v_mfma_f32_16x16x32_bf16 a[0:3], v[112:115], a[124:127], a[0:3]
    v_mfma_f32_16x16x32_bf16 a[4:7], v[120:123], a[124:127], a[4:7]
    buffer_load_dwordx4 a[80:83], v5, s[28:31], s10 offen sc1
    v_mfma_f32_16x16x32_bf16 a[8:11], v[124:127], a[124:127], a[8:11]
    v_mfma_f32_16x16x32_bf16 a[12:15], v[116:119], a[124:127], a[12:15]
    v_mfma_f32_16x16x32_bf16 a[16:19], v[128:131], a[124:127], a[16:19]
    s_waitcnt vmcnt(9)
    v_mfma_f32_16x16x32_bf16 a[0:3], v[132:135], a[128:131], a[0:3]
    v_mfma_f32_16x16x32_bf16 a[4:7], v[136:139], a[128:131], a[4:7]
    buffer_load_dwordx4 a[84:87], v5, s[28:31], s11 offen sc1
    v_mfma_f32_16x16x32_bf16 a[8:11], v[140:143], a[128:131], a[8:11]
    buffer_load_dwordx4 a[88:91], v5, s[28:31], s12 offen sc1
    v_mfma_f32_16x16x32_bf16 a[12:15], v[144:147], a[128:131], a[12:15]
    v_mfma_f32_16x16x32_bf16 a[16:19], v[148:151], a[128:131], a[16:19]
    s_waitcnt vmcnt(9)
    v_mfma_f32_16x16x32_bf16 a[0:3], v[152:155], a[132:135], a[0:3]
    v_mfma_f32_16x16x32_bf16 a[4:7], v[156:159], a[132:135], a[4:7]
    buffer_load_dwordx4 a[92:95], v5, s[28:31], s13 offen sc1
    v_mfma_f32_16x16x32_bf16 a[8:11], v[160:163], a[132:135], a[8:11]
    v_mfma_f32_16x16x32_bf16 a[12:15], v[164:167], a[132:135], a[12:15]
    v_mfma_f32_16x16x32_bf16 a[16:19], v[168:171], a[132:135], a[16:19]
    s_waitcnt vmcnt(9)
    v_mfma_f32_16x16x32_bf16 a[20:23], a[160:163], a[136:139], 0
    v_mfma_f32_16x16x32_bf16 a[24:27], a[164:167], a[136:139], 0
    buffer_load_dwordx4 a[96:99], v5, s[28:31], s14 offen sc1
    v_mfma_f32_16x16x32_bf16 a[28:31], a[168:171], a[136:139], 0
    v_mfma_f32_16x16x32_bf16 a[32:35], a[172:175], a[136:139], 0
    v_mfma_f32_16x16x32_bf16 a[36:39], a[176:179], a[136:139], 0
    s_waitcnt vmcnt(9)
    v_mfma_f32_16x16x32_bf16 a[20:23], a[180:183], a[140:143], a[20:23]
    v_mfma_f32_16x16x32_bf16 a[24:27], a[184:187], a[140:143], a[24:27]
    buffer_load_dwordx4 a[100:103], v5, s[28:31], s15 offen sc1
    v_mfma_f32_16x16x32_bf16 a[28:31], a[188:191], a[140:143], a[28:31]
    ds_write_b128 v29, a[0:3] offset:0
    v_mfma_f32_16x16x32_bf16 a[32:35], a[192:195], a[140:143], a[32:35]
    v_mfma_f32_16x16x32_bf16 a[36:39], a[196:199], a[140:143], a[36:39]
    s_waitcnt vmcnt(9)
    v_mfma_f32_16x16x32_bf16 a[20:23], a[200:203], a[144:147], a[20:23]
    ds_write_b128 v29, a[4:7] offset:32
    v_mfma_f32_16x16x32_bf16 a[24:27], a[204:207], a[144:147], a[24:27]
    buffer_load_dwordx4 a[104:107], v5, s[28:31], s16 offen sc1
    v_mfma_f32_16x16x32_bf16 a[28:31], a[208:211], a[144:147], a[28:31]
    v_mfma_f32_16x16x32_bf16 a[32:35], a[212:215], a[144:147], a[32:35]
    ds_write_b128 v29, a[8:11] offset:64
    v_mfma_f32_16x16x32_bf16 a[36:39], a[216:219], a[144:147], a[36:39]
    s_waitcnt vmcnt(9)
    v_mfma_f32_16x16x32_bf16 a[20:23], a[220:223], a[148:151], a[20:23]
    v_mfma_f32_16x16x32_bf16 a[24:27], a[224:227], a[148:151], a[24:27]
    buffer_load_dwordx4 a[108:111], v5, s[28:31], s17 offen sc1
    v_mfma_f32_16x16x32_bf16 a[28:31], a[228:231], a[148:151], a[28:31]
    ds_write_b128 v29, a[12:15] offset:96
    v_mfma_f32_16x16x32_bf16 a[32:35], a[232:235], a[148:151], a[32:35]
    v_mfma_f32_16x16x32_bf16 a[36:39], a[236:239], a[148:151], a[36:39]
    s_waitcnt vmcnt(9)
    v_mfma_f32_16x16x32_bf16 a[20:23], a[240:243], a[152:155], a[20:23]
    ds_write_b128 v29, a[16:19] offset:128
    v_mfma_f32_16x16x32_bf16 a[24:27], a[244:247], a[152:155], a[24:27]
    buffer_load_dwordx4 a[112:115], v6, s[28:31], s4 offen sc1
    v_mfma_f32_16x16x32_bf16 a[28:31], a[248:251], a[152:155], a[28:31]
    v_mfma_f32_16x16x32_bf16 a[32:35], a[252:255], a[152:155], a[32:35]
    v_mfma_f32_16x16x32_bf16 a[36:39], v[212:215], a[152:155], a[36:39]
    s_waitcnt vmcnt(9)
    v_mfma_f32_16x16x32_bf16 a[20:23], v[216:219], a[156:159], a[20:23]
    v_mfma_f32_16x16x32_bf16 a[24:27], v[220:223], a[156:159], a[24:27]
    buffer_load_dwordx4 a[116:119], v6, s[28:31], s5 offen sc1
    v_mfma_f32_16x16x32_bf16 a[28:31], v[224:227], a[156:159], a[28:31]
    v_mfma_f32_16x16x32_bf16 a[32:35], v[228:231], a[156:159], a[32:35]
    v_mfma_f32_16x16x32_bf16 a[36:39], v[232:235], a[156:159], a[36:39]
    s_waitcnt lgkmcnt(0)
    s_barrier
    s_waitcnt vmcnt(9)
    v_mfma_f32_16x16x32_bf16 a[20:23], v[236:239], a[80:83], a[20:23]
    ds_read_b128 v[172:175], v28 offset:0
    v_mfma_f32_16x16x32_bf16 a[24:27], v[240:243], a[80:83], a[24:27]
    buffer_load_dwordx4 a[120:123], v6, s[28:31], s6 offen sc1
    v_mfma_f32_16x16x32_bf16 a[28:31], v[244:247], a[80:83], a[28:31]
    ds_read_b128 v[176:179], v28 offset:160
    v_mfma_f32_16x16x32_bf16 a[32:35], v[248:251], a[80:83], a[32:35]
    ds_read_b128 v[180:183], v28 offset:6720
    v_mfma_f32_16x16x32_bf16 a[36:39], v[252:255], a[80:83], a[36:39]
    ds_read_b128 v[184:187], v28 offset:6880
    s_waitcnt vmcnt(9)
    v_mfma_f32_16x16x32_bf16 a[20:23], v[32:35], a[84:87], a[20:23]
    ds_read_b128 v[188:191], v28 offset:13440
    v_mfma_f32_16x16x32_bf16 a[24:27], v[40:43], a[84:87], a[24:27]
    buffer_load_dwordx4 a[124:127], v6, s[28:31], s7 offen sc1
    v_mfma_f32_16x16x32_bf16 a[28:31], v[44:47], a[84:87], a[28:31]
    global_load_dword v15, v13, s[42:43] offset:128 sc1
    v_mfma_f32_16x16x32_bf16 a[32:35], v[48:51], a[84:87], a[32:35]
    ds_read_b128 v[192:195], v28 offset:13600
    v_mfma_f32_16x16x32_bf16 a[36:39], v[56:59], a[84:87], a[36:39]
    ds_read_b128 v[196:199], v28 offset:20160
    s_waitcnt vmcnt(10)
    v_mfma_f32_16x16x32_bf16 a[20:23], v[60:63], a[88:91], a[20:23]
    ds_read_b128 v[200:203], v28 offset:20320
    v_mfma_f32_16x16x32_bf16 a[24:27], v[64:67], a[88:91], a[24:27]
    buffer_load_dwordx4 a[128:131], v6, s[28:31], s8 offen sc1
    v_mfma_f32_16x16x32_bf16 a[28:31], v[72:75], a[88:91], a[28:31]
    v_mfma_f32_16x16x32_bf16 a[32:35], v[76:79], a[88:91], a[32:35]
    v_mfma_f32_16x16x32_bf16 a[36:39], v[80:83], a[88:91], a[36:39]
    s_waitcnt vmcnt(10)
    v_mfma_f32_16x16x32_bf16 a[20:23], v[88:91], a[92:95], a[20:23]
    v_mfma_f32_16x16x32_bf16 a[24:27], v[92:95], a[92:95], a[24:27]
    buffer_load_dwordx4 a[132:135], v6, s[28:31], s9 offen sc1
    v_mfma_f32_16x16x32_bf16 a[28:31], v[96:99], a[92:95], a[28:31]
    s_waitcnt lgkmcnt(5)
    v_add_f32 v172, v172, v180
    v_add_f32 v173, v173, v181
    v_mfma_f32_16x16x32_bf16 a[32:35], v[104:107], a[92:95], a[32:35]
    v_add_f32 v174, v174, v182
    v_add_f32 v175, v175, v183
    v_mfma_f32_16x16x32_bf16 a[36:39], v[108:111], a[92:95], a[36:39]
    s_waitcnt lgkmcnt(4)
    v_add_f32 v176, v176, v184
    s_waitcnt vmcnt(10)
    v_mfma_f32_16x16x32_bf16 a[20:23], v[36:39], a[96:99], a[20:23]
    v_add_f32 v177, v177, v185
    v_add_f32 v178, v178, v186
    v_mfma_f32_16x16x32_bf16 a[24:27], v[52:55], a[96:99], a[24:27]
    buffer_load_dwordx4 a[136:139], v6, s[28:31], s10 offen sc1
    v_mfma_f32_16x16x32_bf16 a[28:31], v[68:71], a[96:99], a[28:31]
    v_add_f32 v179, v179, v187
    s_waitcnt lgkmcnt(1)
    v_add_f32 v188, v188, v196
    v_mfma_f32_16x16x32_bf16 a[32:35], v[84:87], a[96:99], a[32:35]
    v_add_f32 v189, v189, v197
    v_add_f32 v190, v190, v198
    v_mfma_f32_16x16x32_bf16 a[36:39], v[100:103], a[96:99], a[36:39]
    v_add_f32 v191, v191, v199
    s_waitcnt vmcnt(10)
    v_mfma_f32_16x16x32_bf16 a[20:23], v[112:115], a[100:103], a[20:23]
    s_waitcnt lgkmcnt(0)
    v_add_f32 v192, v192, v200
    v_add_f32 v193, v193, v201
    v_mfma_f32_16x16x32_bf16 a[24:27], v[120:123], a[100:103], a[24:27]
    buffer_load_dwordx4 a[140:143], v6, s[28:31], s11 offen sc1
    v_mfma_f32_16x16x32_bf16 a[28:31], v[124:127], a[100:103], a[28:31]
    v_add_f32 v194, v194, v202
    v_add_f32 v195, v195, v203
    v_mfma_f32_16x16x32_bf16 a[32:35], v[116:119], a[100:103], a[32:35]
    v_add_f32 v172, v172, v188
    v_add_f32 v173, v173, v189
    v_mfma_f32_16x16x32_bf16 a[36:39], v[128:131], a[100:103], a[36:39]
    v_add_f32 v174, v174, v190
    s_waitcnt vmcnt(10)
    v_mfma_f32_16x16x32_bf16 a[20:23], v[132:135], a[104:107], a[20:23]
    v_add_f32 v175, v175, v191
    v_add_f32 v176, v176, v192
    v_mfma_f32_16x16x32_bf16 a[24:27], v[136:139], a[104:107], a[24:27]
    buffer_load_dwordx4 a[144:147], v6, s[28:31], s12 offen sc1
    v_mfma_f32_16x16x32_bf16 a[28:31], v[140:143], a[104:107], a[28:31]
    v_add_f32 v177, v177, v193
    v_add_f32 v178, v178, v194
    v_mfma_f32_16x16x32_bf16 a[32:35], v[144:147], a[104:107], a[32:35]
    v_add_f32 v179, v179, v195
    v_cvt_pk_bf16_f32 v16, v172, v173
    v_mfma_f32_16x16x32_bf16 a[36:39], v[148:151], a[104:107], a[36:39]
    v_cvt_pk_bf16_f32 v17, v174, v175
    s_waitcnt vmcnt(10)
    v_mfma_f32_16x16x32_bf16 a[20:23], v[152:155], a[108:111], a[20:23]
    v_cvt_pk_bf16_f32 v18, v176, v177
    v_cvt_pk_bf16_f32 v19, v178, v179
    v_mfma_f32_16x16x32_bf16 a[24:27], v[156:159], a[108:111], a[24:27]
    buffer_load_dwordx4 a[148:151], v6, s[28:31], s13 offen sc1
    v_mfma_f32_16x16x32_bf16 a[28:31], v[160:163], a[108:111], a[28:31]
    v_mfma_f32_16x16x32_bf16 a[32:35], v[164:167], a[108:111], a[32:35]
    v_mfma_f32_16x16x32_bf16 a[36:39], v[168:171], a[108:111], a[36:39]
    s_waitcnt vmcnt(10)
    v_mfma_f32_16x16x32_bf16 a[40:43], a[160:163], a[112:115], 0
    v_mfma_f32_16x16x32_bf16 a[44:47], a[164:167], a[112:115], 0
    buffer_load_dwordx4 a[152:155], v6, s[28:31], s14 offen sc1
    v_mfma_f32_16x16x32_bf16 a[48:51], a[168:171], a[112:115], 0
    v_mfma_f32_16x16x32_bf16 a[52:55], a[172:175], a[112:115], 0
    v_mfma_f32_16x16x32_bf16 a[56:59], a[176:179], a[112:115], 0
    s_waitcnt vmcnt(10)
    v_mfma_f32_16x16x32_bf16 a[40:43], a[180:183], a[116:119], a[40:43]
    v_mfma_f32_16x16x32_bf16 a[44:47], a[184:187], a[116:119], a[44:47]
    buffer_load_dwordx4 a[156:159], v6, s[28:31], s15 offen sc1
    v_mfma_f32_16x16x32_bf16 a[48:51], a[188:191], a[116:119], a[48:51]
    ds_write_b128 v29, a[20:23] offset:26880
    v_mfma_f32_16x16x32_bf16 a[52:55], a[192:195], a[116:119], a[52:55]
    v_mfma_f32_16x16x32_bf16 a[56:59], a[196:199], a[116:119], a[56:59]
    s_waitcnt vmcnt(10)
    v_mfma_f32_16x16x32_bf16 a[40:43], a[200:203], a[120:123], a[40:43]
    ds_write_b128 v29, a[24:27] offset:26912
    v_mfma_f32_16x16x32_bf16 a[44:47], a[204:207], a[120:123], a[44:47]
    buffer_load_dwordx4 a[80:83], v6, s[28:31], s16 offen sc1
    v_mfma_f32_16x16x32_bf16 a[48:51], a[208:211], a[120:123], a[48:51]
    v_mfma_f32_16x16x32_bf16 a[52:55], a[212:215], a[120:123], a[52:55]
    ds_write_b128 v29, a[28:31] offset:26944
    v_mfma_f32_16x16x32_bf16 a[56:59], a[216:219], a[120:123], a[56:59]
    s_waitcnt vmcnt(10)
    v_mfma_f32_16x16x32_bf16 a[40:43], a[220:223], a[124:127], a[40:43]
    v_mfma_f32_16x16x32_bf16 a[44:47], a[224:227], a[124:127], a[44:47]
    buffer_load_dwordx4 a[84:87], v6, s[28:31], s17 offen sc1
    v_mfma_f32_16x16x32_bf16 a[48:51], a[228:231], a[124:127], a[48:51]
    s_waitcnt vmcnt(10)
    v_cmp_ne_u32 vcc, s59, v15
    v_mfma_f32_16x16x32_bf16 a[52:55], a[232:235], a[124:127], a[52:55]
    s_cbranch_vccnz L_h2slow
L_h2go:
    v_mfma_f32_16x16x32_bf16 a[56:59], a[236:239], a[124:127], a[56:59]
    s_waitcnt vmcnt(9)
    v_mfma_f32_16x16x32_bf16 a[40:43], a[240:243], a[128:131], a[40:43]
    buffer_load_dwordx4 a[88:91], v7, s[28:31], s4 offen sc1
    v_mfma_f32_16x16x32_bf16 a[44:47], a[244:247], a[128:131], a[44:47]
    ds_write_b128 v29, a[32:35] offset:26976
    v_mfma_f32_16x16x32_bf16 a[48:51], a[248:251], a[128:131], a[48:51]
    v_mfma_f32_16x16x32_bf16 a[52:55], a[252:255], a[128:131], a[52:55]
    v_mfma_f32_16x16x32_bf16 a[56:59], v[212:215], a[128:131], a[56:59]
    s_waitcnt vmcnt(9)
    v_mfma_f32_16x16x32_bf16 a[40:43], v[216:219], a[132:135], a[40:43]
    ds_write_b128 v29, a[36:39] offset:27008
    v_mfma_f32_16x16x32_bf16 a[44:47], v[220:223], a[132:135], a[44:47]
    buffer_load_dwordx4 a[92:95], v7, s[28:31], s5 offen sc1
    v_mfma_f32_16x16x32_bf16 a[48:51], v[224:227], a[132:135], a[48:51]
    v_mfma_f32_16x16x32_bf16 a[52:55], v[228:231], a[132:135], a[52:55]
    v_mfma_f32_16x16x32_bf16 a[56:59], v[232:235], a[132:135], a[56:59]
    s_waitcnt lgkmcnt(0)
    s_barrier
    s_waitcnt vmcnt(9)
    v_mfma_f32_16x16x32_bf16 a[40:43], v[236:239], a[136:139], a[40:43]
    ds_read_b128 v[172:175], v28 offset:26880
    v_mfma_f32_16x16x32_bf16 a[44:47], v[240:243], a[136:139], a[44:47]
    buffer_load_dwordx4 a[96:99], v7, s[28:31], s6 offen sc1
    v_mfma_f32_16x16x32_bf16 a[48:51], v[244:247], a[136:139], a[48:51]
    ds_read_b128 v[176:179], v28 offset:27040
    v_mfma_f32_16x16x32_bf16 a[52:55], v[248:251], a[136:139], a[52:55]
    ds_read_b128 v[180:183], v28 offset:33600
    v_mfma_f32_16x16x32_bf16 a[56:59], v[252:255], a[136:139], a[56:59]
    ds_read_b128 v[184:187], v28 offset:33760
    s_waitcnt vmcnt(9)
    v_mfma_f32_16x16x32_bf16 a[40:43], v[32:35], a[140:143], a[40:43]
    ds_read_b128 v[188:191], v28 offset:40320
    v_mfma_f32_16x16x32_bf16 a[44:47], v[40:43], a[140:143], a[44:47]
    buffer_load_dwordx4 a[100:103], v7, s[28:31], s7 offen sc1
    v_mfma_f32_16x16x32_bf16 a[48:51], v[44:47], a[140:143], a[48:51]
    ds_read_b128 v[192:195], v28 offset:40480
    v_mfma_f32_16x16x32_bf16 a[52:55], v[48:51], a[140:143], a[52:55]
    ds_read_b128 v[196:199], v28 offset:47040
    v_mfma_f32_16x16x32_bf16 a[56:59], v[56:59], a[140:143], a[56:59]
    ds_read_b128 v[200:203], v28 offset:47200
    s_waitcnt vmcnt(9)
    v_mfma_f32_16x16x32_bf16 a[40:43], v[60:63], a[144:147], a[40:43]
    v_mfma_f32_16x16x32_bf16 a[44:47], v[64:67], a[144:147], a[44:47]
    buffer_load_dwordx4 a[104:107], v7, s[28:31], s8 offen sc1
    v_mfma_f32_16x16x32_bf16 a[48:51], v[72:75], a[144:147], a[48:51]
    v_mfma_f32_16x16x32_bf16 a[52:55], v[76:79], a[144:147], a[52:55]
    v_mfma_f32_16x16x32_bf16 a[56:59], v[80:83], a[144:147], a[56:59]
    s_waitcnt vmcnt(9)
    v_mfma_f32_16x16x32_bf16 a[40:43], v[88:91], a[148:151], a[40:43]
    s_waitcnt lgkmcnt(5)
    v_add_f32 v172, v172, v180
    v_add_f32 v173, v173, v181
    v_mfma_f32_16x16x32_bf16 a[44:47], v[92:95], a[148:151], a[44:47]
    buffer_load_dwordx4 a[108:111], v7, s[28:31], s9 offen sc1
    v_mfma_f32_16x16x32_bf16 a[48:51], v[96:99], a[148:151], a[48:51]
    v_add_f32 v174, v174, v182
    v_add_f32 v175, v175, v183
    v_mfma_f32_16x16x32_bf16 a[52:55], v[104:107], a[148:151], a[52:55]
    s_waitcnt lgkmcnt(4)
    v_add_f32 v176, v176, v184
    v_add_f32 v177, v177, v185
    v_mfma_f32_16x16x32_bf16 a[56:59], v[108:111], a[148:151], a[56:59]
    v_add_f32 v178, v178, v186
    s_waitcnt vmcnt(9)
    v_mfma_f32_16x16x32_bf16 a[40:43], v[36:39], a[152:155], a[40:43]
    v_add_f32 v179, v179, v187
    s_waitcnt lgkmcnt(1)
    v_add_f32 v188, v188, v196
    v_mfma_f32_16x16x32_bf16 a[44:47], v[52:55], a[152:155], a[44:47]
    buffer_load_dwordx4 a[112:115], v7, s[28:31], s10 offen sc1
    v_mfma_f32_16x16x32_bf16 a[48:51], v[68:71], a[152:155], a[48:51]
    v_add_f32 v189, v189, v197
    v_add_f32 v190, v190, v198
    v_mfma_f32_16x16x32_bf16 a[52:55], v[84:87], a[152:155], a[52:55]
    v_add_f32 v191, v191, v199
    s_waitcnt lgkmcnt(0)
    v_add_f32 v192, v192, v200
    v_mfma_f32_16x16x32_bf16 a[56:59], v[100:103], a[152:155], a[56:59]
    v_add_f32 v193, v193, v201
    s_waitcnt vmcnt(9)
    v_mfma_f32_16x16x32_bf16 a[40:43], v[112:115], a[156:159], a[40:43]
    v_add_f32 v194, v194, v202
    v_add_f32 v195, v195, v203
    v_mfma_f32_16x16x32_bf16 a[44:47], v[120:123], a[156:159], a[44:47]
    buffer_load_dwordx4 a[116:119], v7, s[28:31], s11 offen sc1
    v_mfma_f32_16x16x32_bf16 a[48:51], v[124:127], a[156:159], a[48:51]
    v_add_f32 v172, v172, v188
    v_add_f32 v173, v173, v189
    v_mfma_f32_16x16x32_bf16 a[52:55], v[116:119], a[156:159], a[52:55]
    v_add_f32 v174, v174, v190
    v_add_f32 v175, v175, v191
    v_mfma_f32_16x16x32_bf16 a[56:59], v[128:131], a[156:159], a[56:59]
    v_add_f32 v176, v176, v192
    s_waitcnt vmcnt(9)
    v_mfma_f32_16x16x32_bf16 a[40:43], v[132:135], a[80:83], a[40:43]
    v_add_f32 v177, v177, v193
    v_add_f32 v178, v178, v194
    v_mfma_f32_16x16x32_bf16 a[44:47], v[136:139], a[80:83], a[44:47]
    buffer_load_dwordx4 a[120:123], v7, s[28:31], s12 offen sc1
    v_mfma_f32_16x16x32_bf16 a[48:51], v[140:143], a[80:83], a[48:51]
    v_add_f32 v179, v179, v195
    v_cvt_pk_bf16_f32 v20, v172, v173
    v_mfma_f32_16x16x32_bf16 a[52:55], v[144:147], a[80:83], a[52:55]
    v_cvt_pk_bf16_f32 v21, v174, v175
    v_cvt_pk_bf16_f32 v22, v176, v177
    v_mfma_f32_16x16x32_bf16 a[56:59], v[148:151], a[80:83], a[56:59]
    v_cvt_pk_bf16_f32 v23, v178, v179
    s_waitcnt vmcnt(9)
    v_mfma_f32_16x16x32_bf16 a[40:43], v[152:155], a[84:87], a[40:43]
    v_mfma_f32_16x16x32_bf16 a[44:47], v[156:159], a[84:87], a[44:47]
    buffer_load_dwordx4 a[124:127], v7, s[28:31], s13 offen sc1
    v_mfma_f32_16x16x32_bf16 a[48:51], v[160:163], a[84:87], a[48:51]
    v_mfma_f32_16x16x32_bf16 a[52:55], v[164:167], a[84:87], a[52:55]
    v_mfma_f32_16x16x32_bf16 a[56:59], v[168:171], a[84:87], a[56:59]
    s_waitcnt vmcnt(9)
    v_mfma_f32_16x16x32_bf16 a[60:63], a[160:163], a[88:91], 0
    v_mfma_f32_16x16x32_bf16 a[64:67], a[164:167], a[88:91], 0
    buffer_load_dwordx4 a[128:131], v7, s[28:31], s14 offen sc1
    v_mfma_f32_16x16x32_bf16 a[68:71], a[168:171], a[88:91], 0
    v_mfma_f32_16x16x32_bf16 a[72:75], a[172:175], a[88:91], 0
    v_mfma_f32_16x16x32_bf16 a[76:79], a[176:179], a[88:91], 0
    s_waitcnt vmcnt(9)
    v_mfma_f32_16x16x32_bf16 a[60:63], a[180:183], a[92:95], a[60:63]
    v_mfma_f32_16x16x32_bf16 a[64:67], a[184:187], a[92:95], a[64:67]
    buffer_load_dwordx4 a[132:135], v7, s[28:31], s15 offen sc1
    v_mfma_f32_16x16x32_bf16 a[68:71], a[188:191], a[92:95], a[68:71]
    ds_write_b128 v27, a[40:43] offset:0
    v_mfma_f32_16x16x32_bf16 a[72:75], a[192:195], a[92:95], a[72:75]
    v_mfma_f32_16x16x32_bf16 a[76:79], a[196:199], a[92:95], a[76:79]
    s_waitcnt vmcnt(9)
    v_mfma_f32_16x16x32_bf16 a[60:63], a[200:203], a[96:99], a[60:63]
    ds_write_b128 v27, a[44:47] offset:32
    v_mfma_f32_16x16x32_bf16 a[64:67], a[204:207], a[96:99], a[64:67]
    buffer_load_dwordx4 a[136:139], v7, s[28:31], s16 offen sc1
    v_mfma_f32_16x16x32_bf16 a[68:71], a[208:211], a[96:99], a[68:71]
    v_mfma_f32_16x16x32_bf16 a[72:75], a[212:215], a[96:99], a[72:75]
    ds_write_b128 v27, a[48:51] offset:64
    v_mfma_f32_16x16x32_bf16 a[76:79], a[216:219], a[96:99], a[76:79]
    s_waitcnt vmcnt(9)
    v_mfma_f32_16x16x32_bf16 a[60:63], a[220:223], a[100:103], a[60:63]
    v_mfma_f32_16x16x32_bf16 a[64:67], a[224:227], a[100:103], a[64:67]
    buffer_load_dwordx4 a[140:143], v7, s[28:31], s17 offen sc1
    v_mfma_f32_16x16x32_bf16 a[68:71], a[228:231], a[100:103], a[68:71]
    ds_write_b128 v27, a[52:55] offset:96
    v_mfma_f32_16x16x32_bf16 a[72:75], a[232:235], a[100:103], a[72:75]
    v_mfma_f32_16x16x32_bf16 a[76:79], a[236:239], a[100:103], a[76:79]
    s_waitcnt vmcnt(9)
    v_mfma_f32_16x16x32_bf16 a[60:63], a[240:243], a[104:107], a[60:63]
    ds_write_b128 v27, a[56:59] offset:128
    v_mfma_f32_16x16x32_bf16 a[64:67], a[244:247], a[104:107], a[64:67]
    v_mfma_f32_16x16x32_bf16 a[68:71], a[248:251], a[104:107], a[68:71]
    v_mfma_f32_16x16x32_bf16 a[72:75], a[252:255], a[104:107], a[72:75]
    s_mov_b32 s19, 0
    v_mfma_f32_16x16x32_bf16 a[76:79], v[212:215], a[104:107], a[76:79]
    s_waitcnt vmcnt(8)
    v_mfma_f32_16x16x32_bf16 a[60:63], v[216:219], a[108:111], a[60:63]
    buffer_store_dwordx4 v[16:19], v30, s[36:39], s19 offen sc1
L_pad3:
    s_cbranch_execz L_padret
    v_mfma_f32_16x16x32_bf16 a[64:67], v[220:223], a[108:111], a[64:67]
    s_mov_b32 s19, 81920
    v_mfma_f32_16x16x32_bf16 a[68:71], v[224:227], a[108:111], a[68:71]
    buffer_store_dwordx4 v[20:23], v30, s[36:39], s19 offen sc1
    v_mfma_f32_16x16x32_bf16 a[72:75], v[228:231], a[108:111], a[72:75]
    v_mfma_f32_16x16x32_bf16 a[76:79], v[232:235], a[108:111], a[76:79]
    s_waitcnt lgkmcnt(0)
    s_barrier
    s_waitcnt vmcnt(9)
    v_mfma_f32_16x16x32_bf16 a[60:63], v[236:239], a[112:115], a[60:63]
    ds_read_b128 v[172:175], v26 offset:0
    v_mfma_f32_16x16x32_bf16 a[64:67], v[240:243], a[112:115], a[64:67]
    ds_read_b128 v[176:179], v26 offset:160
    v_mfma_f32_16x16x32_bf16 a[68:71], v[244:247], a[112:115], a[68:71]
    ds_read_b128 v[180:183], v26 offset:6720
    v_mfma_f32_16x16x32_bf16 a[72:75], v[248:251], a[112:115], a[72:75]
    ds_read_b128 v[184:187], v26 offset:6880
    v_mfma_f32_16x16x32_bf16 a[76:79], v[252:255], a[112:115], a[76:79]
    ds_read_b128 v[188:191], v26 offset:13440
    s_waitcnt vmcnt(8)
    v_mfma_f32_16x16x32_bf16 a[60:63], v[32:35], a[116:119], a[60:63]
    ds_read_b128 v[192:195], v26 offset:13600
    v_mfma_f32_16x16x32_bf16 a[64:67], v[40:43], a[116:119], a[64:67]
    ds_read_b128 v[196:199], v26 offset:20160
    v_mfma_f32_16x16x32_bf16 a[68:71], v[44:47], a[116:119], a[68:71]
    ds_read_b128 v[200:203], v26 offset:20320
    v_mfma_f32_16x16x32_bf16 a[72:75], v[48:51], a[116:119], a[72:75]
    v_mfma_f32_16x16x32_bf16 a[76:79], v[56:59], a[116:119], a[76:79]
    s_waitcnt vmcnt(7)
    v_mfma_f32_16x16x32_bf16 a[60:63], v[60:63], a[120:123], a[60:63]
    v_mfma_f32_16x16x32_bf16 a[64:67], v[64:67], a[120:123], a[64:67]
    v_mfma_f32_16x16x32_bf16 a[68:71], v[72:75], a[120:123], a[68:71]
    v_mfma_f32_16x16x32_bf16 a[72:75], v[76:79], a[120:123], a[72:75]
    s_waitcnt lgkmcnt(5)
    v_add_f32 v172, v172, v180
    v_add_f32 v173, v173, v181
    v_mfma_f32_16x16x32_bf16 a[76:79], v[80:83], a[120:123], a[76:79]
    v_add_f32 v174, v174, v182
    s_waitcnt vmcnt(6)
    v_mfma_f32_16x16x32_bf16 a[60:63], v[88:91], a[124:127], a[60:63]
    v_add_f32 v175, v175, v183
    s_waitcnt lgkmcnt(4)
    v_add_f32 v176, v176, v184
    v_mfma_f32_16x16x32_bf16 a[64:67], v[92:95], a[124:127], a[64:67]
    v_add_f32 v177, v177, v185
    v_add_f32 v178, v178, v186
    v_mfma_f32_16x16x32_bf16 a[68:71], v[96:99], a[124:127], a[68:71]
    v_add_f32 v179, v179, v187
    s_waitcnt lgkmcnt(1)
    v_add_f32 v188, v188, v196
    v_mfma_f32_16x16x32_bf16 a[72:75], v[104:107], a[124:127], a[72:75]
    v_add_f32 v189, v189, v197
    v_add_f32 v190, v190, v198
    v_mfma_f32_16x16x32_bf16 a[76:79], v[108:111], a[124:127], a[76:79]
    v_add_f32 v191, v191, v199
    s_waitcnt vmcnt(5)
    v_mfma_f32_16x16x32_bf16 a[60:63], v[36:39], a[128:131], a[60:63]
    s_waitcnt lgkmcnt(0)
    v_add_f32 v192, v192, v200
    v_add_f32 v193, v193, v201
    v_mfma_f32_16x16x32_bf16 a[64:67], v[52:55], a[128:131], a[64:67]
    v_add_f32 v194, v194, v202
    v_add_f32 v195, v195, v203
    v_mfma_f32_16x16x32_bf16 a[68:71], v[68:71], a[128:131], a[68:71]
    v_add_f32 v172, v172, v188
    v_add_f32 v173, v173, v189
    v_mfma_f32_16x16x32_bf16 a[72:75], v[84:87], a[128:131], a[72:75]
    v_add_f32 v174, v174, v190
    v_add_f32 v175, v175, v191
    v_mfma_f32_16x16x32_bf16 a[76:79], v[100:103], a[128:131], a[76:79]
    v_add_f32 v176, v176, v192
    s_waitcnt vmcnt(4)
    v_mfma_f32_16x16x32_bf16 a[60:63], v[112:115], a[132:135], a[60:63]
    v_add_f32 v177, v177, v193
    v_add_f32 v178, v178, v194
    v_mfma_f32_16x16x32_bf16 a[64:67], v[120:123], a[132:135], a[64:67]
    v_add_f32 v179, v179, v195
    v_cvt_pk_bf16_f32 v204, v172, v173
    v_mfma_f32_16x16x32_bf16 a[68:71], v[124:127], a[132:135], a[68:71]
    v_cvt_pk_bf16_f32 v205, v174, v175
    v_cvt_pk_bf16_f32 v206, v176, v177
    v_mfma_f32_16x16x32_bf16 a[72:75], v[116:119], a[132:135], a[72:75]
    v_cvt_pk_bf16_f32 v207, v178, v179
    s_mov_b32 s19, 163840
    v_mfma_f32_16x16x32_bf16 a[76:79], v[128:131], a[132:135], a[76:79]
    s_waitcnt vmcnt(3)
    v_mfma_f32_16x16x32_bf16 a[60:63], v[132:135], a[136:139], a[60:63]
    buffer_store_dwordx4 v[204:207], v30, s[36:39], s19 offen sc1
    v_mfma_f32_16x16x32_bf16 a[64:67], v[136:139], a[136:139], a[64:67]
    v_mfma_f32_16x16x32_bf16 a[68:71], v[140:143], a[136:139], a[68:71]
    v_mfma_f32_16x16x32_bf16 a[72:75], v[144:147], a[136:139], a[72:75]
    v_mfma_f32_16x16x32_bf16 a[76:79], v[148:151], a[136:139], a[76:79]
    s_waitcnt vmcnt(3)
    v_mfma_f32_16x16x32_bf16 a[60:63], v[152:155], a[140:143], a[60:63]
    v_mfma_f32_16x16x32_bf16 a[64:67], v[156:159], a[140:143], a[64:67]
    v_mfma_f32_16x16x32_bf16 a[68:71], v[160:163], a[140:143], a[68:71]
    v_mfma_f32_16x16x32_bf16 a[72:75], v[164:167], a[140:143], a[72:75]
    v_mfma_f32_16x16x32_bf16 a[76:79], v[168:171], a[140:143], a[76:79]
    s_nop 3
    ds_write_b128 v27, a[60:63] offset:26880
    ds_write_b128 v27, a[64:67] offset:26912
    ds_write_b128 v27, a[68:71] offset:26944
    ds_write_b128 v27, a[72:75] offset:26976
    ds_write_b128 v27, a[76:79] offset:27008
    s_mov_b32 s19, 245760
    s_waitcnt lgkmcnt(0)
    s_barrier
    ds_read_b128 v[172:175], v26 offset:26880
    ds_read_b128 v[180:183], v26 offset:33600
    ds_read_b128 v[188:191], v26 offset:40320
    ds_read_b128 v[196:199], v26 offset:47040
    ds_read_b128 v[176:179], v26 offset:27040
    ds_read_b128 v[184:187], v26 offset:33760
    ds_read_b128 v[192:195], v26 offset:40480
    ds_read_b128 v[200:203], v26 offset:47200
    s_waitcnt lgkmcnt(6)
    v_pk_add_f32 v[172:173], v[172:173], v[180:181]
    v_pk_add_f32 v[174:175], v[174:175], v[182:183]
    s_waitcnt lgkmcnt(4)
    v_pk_add_f32 v[188:189], v[188:189], v[196:197]
    v_pk_add_f32 v[190:191], v[190:191], v[198:199]
    v_pk_add_f32 v[172:173], v[172:173], v[188:189]
    v_pk_add_f32 v[174:175], v[174:175], v[190:191]
    v_cvt_pk_bf16_f32 v8, v172, v173
    v_cvt_pk_bf16_f32 v9, v174, v175
    s_waitcnt lgkmcnt(2)
    v_pk_add_f32 v[176:177], v[176:177], v[184:185]
    v_pk_add_f32 v[178:179], v[178:179], v[186:187]
    s_waitcnt lgkmcnt(0)
    v_pk_add_f32 v[192:193], v[192:193], v[200:201]
    v_pk_add_f32 v[194:195], v[194:195], v[202:203]
    v_pk_add_f32 v[176:177], v[176:177], v[192:193]
    v_pk_add_f32 v[178:179], v[178:179], v[194:195]
    v_cvt_pk_bf16_f32 v10, v176, v177
    v_cvt_pk_bf16_f32 v11, v178, v179
    buffer_store_dwordx4 v[8:11], v30, s[36:39], s19 offen
    s_endpgm
L_wdslow:
    s_add_u32 s75, s75, 1
    s_cmp_gt_u32 s75, 400000
    s_cbranch_scc1 L_wdback
    s_sleep 2
    v_mov_b32 v15, 0
    global_load_dword v15, v15, s[46:47] offset:128 sc1
    s_waitcnt vmcnt(0)
    v_readfirstlane_b32 s59, v15
    s_cmp_eq_u32 s59, 0
    s_cbranch_scc1 L_wdslow
    s_branch L_wdback
L_hslow:
    s_add_u32 s75, s75, 1
    s_cmp_gt_u32 s75, 400000
    s_cbranch_scc1 L_hgo
    s_sleep 2
    global_load_dword v15, v13, s[42:43] offset:0 sc1
    s_waitcnt vmcnt(0)
    v_cmp_ne_u32 vcc, s59, v15
    s_cbranch_vccnz L_hslow
    s_branch L_hgo
L_h2slow:
    s_add_u32 s75, s75, 1
    s_cmp_gt_u32 s75, 400000
    s_cbranch_scc1 L_h2go
    s_sleep 2
    global_load_dword v15, v13, s[42:43] offset:128 sc1
    s_waitcnt vmcnt(0)
    v_cmp_ne_u32 vcc, s59, v15
    s_cbranch_vccnz L_h2slow
    s_branch L_h2go
L_spare:
    s_bfe_u32 s58, s2, 0x20003
    s_and_b32 s60, s2, 7
    s_cmp_eq_u32 s19, 7
    s_cselect_b32 s61, 0, 2
    s_add_u32 s60, s60, s61
    s_lshl2_add_u32 s60, s60, s58
    s_lshl2_add_u32 s57, s60, s56
    s_mul_i32 s74, s56, 40
    s_add_u32 s74, s74, s60
    v_lshrrev_b32 v4, 3, v1
    v_lshrrev_b32 v6, 4, v1
    v_and_b32 v12, 1, v6
    v_lshlrev_b32 v12, 1, v12
    v_xor_b32 v12, v5, v12
    v_mul_u32_u24 v14, 1280, v4
    v_lshl_add_u32 v16, v12, 4, v14
    v_xor_b32 v13, 64, v16
    v_add_u32 v17, 9216, v13
    v_add_u32 v18, 18432, v16
    v_add_u32 v19, 27648, v13
    s_lshl_b32 s73, s56, 14
    s_waitcnt lgkmcnt(0)
    s_mov_b64 s[48:49], s[10:11]
    s_mov_b32 s50, 2211840
    s_mov_b32 s51, 0x00020000
    s_mov_b64 s[20:21], s[4:5]
    s_mov_b32 s22, 2621440
    s_mov_b32 s23, 0x00020000
    s_mov_b64 s[24:25], s[6:7]
    s_mov_b32 s26, 2211840
    s_mov_b32 s27, 0x00020000
    s_add_u32 s62, s57, 0
    s_mul_i32 s60, s62, 6554
    s_lshr_b32 s60, s60, 16
    s_mul_i32 s61, s60, 10
    s_sub_u32 s61, s62, s61
    s_mul_i32 s63, s60, 40960
    s_lshl_b32 s61, s61, 7
    s_add_u32 s63, s63, s61
    s_add_u32 m0, s73, 0
    s_nop 0
    buffer_load_dwordx4 v16, s[48:51], s63 offen lds
    buffer_load_dwordx4 v17, s[48:51], s63 offen offset:1024 lds
    buffer_load_dwordx4 v18, s[48:51], s63 offen offset:2048 lds
    buffer_load_dwordx4 v19, s[48:51], s63 offen offset:3072 lds
    s_add_u32 s62, s57, 160
    s_mul_i32 s60, s62, 6554
    s_lshr_b32 s60, s60, 16
    s_mul_i32 s61, s60, 10
    s_sub_u32 s61, s62, s61
    s_mul_i32 s63, s60, 40960
    s_lshl_b32 s61, s61, 7
    s_add_u32 s63, s63, s61
    s_add_u32 m0, s73, 4096
    s_nop 0
    buffer_load_dwordx4 v16, s[48:51], s63 offen lds
    buffer_load_dwordx4 v17, s[48:51], s63 offen offset:1024 lds
    buffer_load_dwordx4 v18, s[48:51], s63 offen offset:2048 lds
    buffer_load_dwordx4 v19, s[48:51], s63 offen offset:3072 lds
    s_add_u32 s62, s57, 320
    s_mul_i32 s60, s62, 6554
    s_lshr_b32 s60, s60, 16
    s_mul_i32 s61, s60, 10
    s_sub_u32 s61, s62, s61
    s_mul_i32 s63, s60, 40960
    s_lshl_b32 s61, s61, 7
    s_add_u32 s63, s63, s61
    s_add_u32 m0, s73, 8192
    s_nop 0
    buffer_load_dwordx4 v16, s[48:51], s63 offen lds
    buffer_load_dwordx4 v17, s[48:51], s63 offen offset:1024 lds
    buffer_load_dwordx4 v18, s[48:51], s63 offen offset:2048 lds
    buffer_load_dwordx4 v19, s[48:51], s63 offen offset:3072 lds
    s_add_u32 s62, s74, 480
    s_mul_i32 s60, s62, 6554
    s_lshr_b32 s60, s60, 16
    s_mul_i32 s61, s60, 10
    s_sub_u32 s61, s62, s61
    s_mul_i32 s63, s60, 40960
    s_lshl_b32 s61, s61, 7
    s_add_u32 s63, s63, s61
    s_add_u32 m0, s73, 12288
    s_nop 0
    buffer_load_dwordx4 v16, s[48:51], s63 offen lds
    buffer_load_dwordx4 v17, s[48:51], s63 offen offset:1024 lds
    buffer_load_dwordx4 v18, s[48:51], s63 offen offset:2048 lds
    buffer_load_dwordx4 v19, s[48:51], s63 offen offset:3072 lds
    v_and_b32 v5, 15, v1
    v_lshrrev_b32 v7, 2, v5
    v_lshl_add_u32 v8, v6, 3, v7
    v_lshrrev_b32 v9, 1, v7
    v_and_b32 v10, 1, v6
    v_lshl_add_u32 v9, v10, 1, v9
    v_and_b32 v10, 3, v1
    v_lshlrev_b32 v10, 3, v10
    v_lshl_add_u32 v8, v8, 7, v10
    v_add_u32 v8, s73, v8
    v_xor_b32 v10, 0, v9
    v_lshl_add_u32 v20, v10, 5, v8
    v_xor_b32 v10, 1, v9
    v_lshl_add_u32 v21, v10, 5, v8
    v_xor_b32 v10, 2, v9
    v_lshl_add_u32 v22, v10, 5, v8
    v_xor_b32 v10, 3, v9
    v_lshl_add_u32 v23, v10, 5, v8
    v_lshlrev_b32 v24, 4, v1
    v_add_u32 v25, 55296, v24
    v_add_u32 v26, 110592, v24
    v_add_u32 v27, 165888, v24
    s_mov_b32 s67, 1792
    s_add_u32 s28, s16, 0
    s_addc_u32 s29, s17, 0
    s_mov_b32 s30, 7077888
    s_mov_b32 s31, 0x00020000
    s_add_u32 s32, s16, 8519680
    s_addc_u32 s33, s17, 0
    s_mov_b32 s34, 2211840
    s_mov_b32 s35, 0x00020000
    s_mov_b64 s[46:47], s[14:15]
    s_add_u32 s42, s16, 8388608
    s_addc_u32 s43, s17, 0
    s_add_u32 s40, s42, s67
    s_addc_u32 s41, s43, 0
    s_mov_b64 s[36:37], s[12:13]
    s_mov_b32 s38, 2621440
    s_mov_b32 s39, 0x00020000
    s_lshr_b32 s60, s2, 5
    s_bfe_u32 s76, s2, 0x20001
    s_lshl3_add_u32 s76, s76, s60
    s_and_b32 s60, s76, 0xfc
    s_add_u32 s60, s60, s56
    s_lshl_b32 s60, s60, 11
    s_add_u32 s42, s42, s60
    s_addc_u32 s43, s43, 0
    s_mov_b32 s75, 0
    s_lshr_b32 s62, s2, 5
    s_bfe_u32 s63, s2, 0x20003
    s_and_b32 s77, s2, 1
    s_lshl2_add_u32 s77, s77, s63
    s_mul_i32 s60, s77, 270
    s_mul_i32 s61, s56, 14
    s_add_u32 s60, s60, s61
    s_lshl_b32 s60, s60, 10
    v_lshl_add_u32 v8, v1, 4, s60
    v_add_u32 v9, 55296, v8
    v_add_u32 v10, 110592, v8
    v_add_u32 v11, 165888, v8
    v_add_u32 v12, 221184, v8
    s_add_u32 s60, s56, 1
    s_lshr_b32 s60, s60, 2
    s_sub_u32 s60, 6, s60
    s_lshl1_add_u32 s64, s60, 1
    v_min_u32 v13, s60, v1
    v_lshlrev_b32 v13, 8, v13
    s_mul_i32 s62, s62, 0
    s_mul_i32 s63, s63, 14
    s_add_u32 s62, s62, s63
    s_lshr_b32 s62, s62, 2
    v_add_u32 v2, s62, v1
    v_subrev_u32 v4, 14, v2
    v_min_u32 v2, v2, v4
    v_subrev_u32 v4, 14, v2
    v_min_u32 v2, v2, v4
    v_sub_u32 v4, s64, v2
    v_and_b32 v4, 2147483648, v4
    v_lshl_or_b32 v2, v2, 10, v4
    s_nop 0
    v_readlane_b32 s4, v2, 0
    v_readlane_b32 s5, v2, 1
    v_readlane_b32 s6, v2, 2
    v_readlane_b32 s7, v2, 3
    v_readlane_b32 s8, v2, 4
    v_readlane_b32 s9, v2, 5
    v_readlane_b32 s10, v2, 6
    v_readlane_b32 s11, v2, 7
    v_readlane_b32 s12, v2, 8
    v_readlane_b32 s13, v2, 9
    v_readlane_b32 s14, v2, 10
    v_readlane_b32 s15, v2, 11
    v_readlane_b32 s16, v2, 12
    v_readlane_b32 s17, v2, 13
    s_waitcnt vmcnt(12)
    ds_read_b64_tr_b16 v[32:33], v20 offset:0
    ds_read_b64_tr_b16 v[34:35], v20 offset:512
    ds_read_b64_tr_b16 v[36:37], v21 offset:0
    ds_read_b64_tr_b16 v[38:39], v21 offset:512
    ds_read_b64_tr_b16 v[40:41], v22 offset:0
    ds_read_b64_tr_b16 v[42:43], v22 offset:512
    ds_read_b64_tr_b16 v[44:45], v23 offset:0
    ds_read_b64_tr_b16 v[46:47], v23 offset:512
    s_add_u32 s62, s57, 0
    s_mul_i32 s60, s62, 6554
    s_lshr_b32 s60, s60, 16
    s_mul_i32 s61, s60, 10
    s_sub_u32 s61, s62, s61
    s_mul_i32 s61, s61, 216
    s_add_u32 s61, s61, s60
    s_lshl_b32 s61, s61, 10
    s_cmp_ge_u32 s60, 54
    s_cselect_b32 s61, 2147483648, s61
    s_waitcnt lgkmcnt(0)
    buffer_store_dwordx4 v[32:35], v24, s[32:35], s61 offen sc1
    buffer_store_dwordx4 v[36:39], v25, s[32:35], s61 offen sc1
    buffer_store_dwordx4 v[40:43], v26, s[32:35], s61 offen sc1
    buffer_store_dwordx4 v[44:47], v27, s[32:35], s61 offen sc1
    s_waitcnt vmcnt(12)
    ds_read_b64_tr_b16 v[48:49], v20 offset:4096
    ds_read_b64_tr_b16 v[50:51], v20 offset:4608
    ds_read_b64_tr_b16 v[52:53], v21 offset:4096
    ds_read_b64_tr_b16 v[54:55], v21 offset:4608
    ds_read_b64_tr_b16 v[56:57], v22 offset:4096
    ds_read_b64_tr_b16 v[58:59], v22 offset:4608
    ds_read_b64_tr_b16 v[60:61], v23 offset:4096
    ds_read_b64_tr_b16 v[62:63], v23 offset:4608
    s_add_u32 s62, s57, 160
    s_mul_i32 s60, s62, 6554
    s_lshr_b32 s60, s60, 16
    s_mul_i32 s61, s60, 10
    s_sub_u32 s61, s62, s61
    s_mul_i32 s61, s61, 216
    s_add_u32 s61, s61, s60
    s_lshl_b32 s61, s61, 10
    s_cmp_ge_u32 s60, 54
    s_cselect_b32 s61, 2147483648, s61
    s_waitcnt lgkmcnt(0)
    buffer_store_dwordx4 v[48:51], v24, s[32:35], s61 offen sc1
    buffer_store_dwordx4 v[52:55], v25, s[32:35], s61 offen sc1
    buffer_store_dwordx4 v[56:59], v26, s[32:35], s61 offen sc1
    buffer_store_dwordx4 v[60:63], v27, s[32:35], s61 offen sc1
    s_waitcnt vmcnt(12)
    ds_read_b64_tr_b16 v[64:65], v20 offset:8192
    ds_read_b64_tr_b16 v[66:67], v20 offset:8704
    ds_read_b64_tr_b16 v[68:69], v21 offset:8192
    ds_read_b64_tr_b16 v[70:71], v21 offset:8704
    ds_read_b64_tr_b16 v[72:73], v22 offset:8192
    ds_read_b64_tr_b16 v[74:75], v22 offset:8704
    ds_read_b64_tr_b16 v[76:77], v23 offset:8192
    ds_read_b64_tr_b16 v[78:79], v23 offset:8704
    s_add_u32 s62, s57, 320
    s_mul_i32 s60, s62, 6554
    s_lshr_b32 s60, s60, 16
    s_mul_i32 s61, s60, 10
    s_sub_u32 s61, s62, s61
    s_mul_i32 s61, s61, 216
    s_add_u32 s61, s61, s60
    s_lshl_b32 s61, s61, 10
    s_cmp_ge_u32 s60, 54
    s_cselect_b32 s61, 2147483648, s61
    s_waitcnt lgkmcnt(0)
    buffer_store_dwordx4 v[64:67], v24, s[32:35], s61 offen sc1
    buffer_store_dwordx4 v[68:71], v25, s[32:35], s61 offen sc1
    buffer_store_dwordx4 v[72:75], v26, s[32:35], s61 offen sc1
    buffer_store_dwordx4 v[76:79], v27, s[32:35], s61 offen sc1
    s_waitcnt vmcnt(12)
    ds_read_b64_tr_b16 v[80:81], v20 offset:12288
    ds_read_b64_tr_b16 v[82:83], v20 offset:12800
    ds_read_b64_tr_b16 v[84:85], v21 offset:12288
    ds_read_b64_tr_b16 v[86:87], v21 offset:12800
    ds_read_b64_tr_b16 v[88:89], v22 offset:12288
    ds_read_b64_tr_b16 v[90:91], v22 offset:12800
    ds_read_b64_tr_b16 v[92:93], v23 offset:12288
    ds_read_b64_tr_b16 v[94:95], v23 offset:12800
    s_add_u32 s62, s74, 480
    s_mul_i32 s60, s62, 6554
    s_lshr_b32 s60, s60, 16
    s_mul_i32 s61, s60, 10
    s_sub_u32 s61, s62, s61
    s_mul_i32 s61, s61, 216
    s_add_u32 s61, s61, s60
    s_lshl_b32 s61, s61, 10
    s_cmp_ge_u32 s60, 54
    s_cselect_b32 s61, 2147483648, s61
    s_waitcnt lgkmcnt(0)
    buffer_store_dwordx4 v[80:83], v24, s[32:35], s61 offen sc1
    buffer_store_dwordx4 v[84:87], v25, s[32:35], s61 offen sc1
    buffer_store_dwordx4 v[88:91], v26, s[32:35], s61 offen sc1
    buffer_store_dwordx4 v[92:95], v27, s[32:35], s61 offen sc1
    s_waitcnt vmcnt(0)
    s_barrier
    s_mov_b32 s64, 1
    s_cmp_lg_u32 s56, 0
    s_cbranch_scc1 L_sp_noarr
    s_atomic_add s64, s[46:47], 0x0 glc
    s_memrealtime s[62:63]
    s_waitcnt lgkmcnt(0)
    s_cmp_lg_u32 s64, 39
    s_cbranch_scc1 L_sp_noarr
    s_or_b32 s65, s62, 1
    s_atomic_swap s65, s[46:47], 0x80
L_sp_noarr:
    s_and_b32 s60, s2, 1
    s_lshl2_add_u32 s60, s60, s58
    s_lshl4_add_u32 s60, s60, s56
    s_add_u32 s60, s60, 12
    s_mul_i32 s60, s60, 20480
    s_cmp_eq_u32 s19, 7
    s_cselect_b32 s60, s60, 2147483648
    v_lshlrev_b32 v2, 7, v1
    buffer_load_dword v3, v2, s[20:23], s60 offen
    s_add_u32 s60, s60, 8192
    buffer_load_dword v3, v2, s[20:23], s60 offen
    s_add_u32 s60, s60, 8192
    s_mov_b32 exec_hi, 0
    buffer_load_dword v3, v2, s[20:23], s60 offen
    s_mov_b32 exec_hi, -1
    s_cmp_lg_u32 s56, 0
    s_cbranch_scc1 L_sp_join
    s_cmp_eq_u32 s64, 39
    s_cbranch_scc1 L_sp_join
L_sp_wd:
    s_add_u32 s75, s75, 1
    s_cmp_gt_u32 s75, 400000
    s_cbranch_scc1 L_sp_join
    s_sleep 4
    s_mov_b32 s64, 0
    s_atomic_add s64, s[46:47], 0x0 glc
    s_waitcnt lgkmcnt(0)
    s_cmp_lt_u32 s64, 40
    s_cbranch_scc1 L_sp_wd
L_sp_join:
    s_barrier
    buffer_load_dwordx4 a[160:163], v8, s[32:35], s4 offen sc1
    buffer_load_dwordx4 a[164:167], v9, s[32:35], s4 offen sc1
    buffer_load_dwordx4 a[168:171], v10, s[32:35], s4 offen sc1
    buffer_load_dwordx4 a[172:175], v11, s[32:35], s4 offen sc1
    buffer_load_dwordx4 a[176:179], v12, s[32:35], s4 offen sc1
    buffer_load_dwordx4 a[180:183], v8, s[32:35], s5 offen sc1
    buffer_load_dwordx4 a[184:187], v9, s[32:35], s5 offen sc1
    buffer_load_dwordx4 a[188:191], v10, s[32:35], s5 offen sc1
    buffer_load_dwordx4 a[192:195], v11, s[32:35], s5 offen sc1
    buffer_load_dwordx4 a[196:199], v12, s[32:35], s5 offen sc1
    buffer_load_dwordx4 a[200:203], v8, s[32:35], s6 offen sc1
    buffer_load_dwordx4 a[204:207], v9, s[32:35], s6 offen sc1
    buffer_load_dwordx4 a[208:211], v10, s[32:35], s6 offen sc1
    buffer_load_dwordx4 a[212:215], v11, s[32:35], s6 offen sc1
    buffer_load_dwordx4 a[216:219], v12, s[32:35], s6 offen sc1
    buffer_load_dwordx4 a[220:223], v8, s[32:35], s7 offen sc1
    buffer_load_dwordx4 a[224:227], v9, s[32:35], s7 offen sc1
    buffer_load_dwordx4 a[228:231], v10, s[32:35], s7 offen sc1
    buffer_load_dwordx4 a[232:235], v11, s[32:35], s7 offen sc1
    buffer_load_dwordx4 a[236:239], v12, s[32:35], s7 offen sc1
    buffer_load_dwordx4 a[240:243], v8, s[32:35], s8 offen sc1
    buffer_load_dwordx4 a[244:247], v9, s[32:35], s8 offen sc1
    buffer_load_dwordx4 a[248:251], v10, s[32:35], s8 offen sc1
    buffer_load_dwordx4 a[252:255], v11, s[32:35], s8 offen sc1
    buffer_load_dwordx4 v[212:215], v12, s[32:35], s8 offen sc1
    buffer_load_dwordx4 v[216:219], v8, s[32:35], s9 offen sc1
    buffer_load_dwordx4 v[220:223], v9, s[32:35], s9 offen sc1
    buffer_load_dwordx4 v[224:227], v10, s[32:35], s9 offen sc1
    buffer_load_dwordx4 v[228:231], v11, s[32:35], s9 offen sc1
    buffer_load_dwordx4 v[232:235], v12, s[32:35], s9 offen sc1
    buffer_load_dwordx4 v[236:239], v8, s[32:35], s10 offen sc1
    buffer_load_dwordx4 v[240:243], v9, s[32:35], s10 offen sc1
    buffer_load_dwordx4 v[244:247], v10, s[32:35], s10 offen sc1
    buffer_load_dwordx4 v[248:251], v11, s[32:35], s10 offen sc1
    buffer_load_dwordx4 v[252:255], v12, s[32:35], s10 offen sc1
    buffer_load_dwordx4 v[32:35], v8, s[32:35], s11 offen sc1
    buffer_load_dwordx4 v[40:43], v9, s[32:35], s11 offen sc1
    buffer_load_dwordx4 v[44:47], v10, s[32:35], s11 offen sc1
    buffer_load_dwordx4 v[48:51], v11, s[32:35], s11 offen sc1
    buffer_load_dwordx4 v[56:59], v12, s[32:35], s11 offen sc1
    buffer_load_dwordx4 v[60:63], v8, s[32:35], s12 offen sc1
    buffer_load_dwordx4 v[64:67], v9, s[32:35], s12 offen sc1
    buffer_load_dwordx4 v[72:75], v10, s[32:35], s12 offen sc1
    buffer_load_dwordx4 v[76:79], v11, s[32:35], s12 offen sc1
    buffer_load_dwordx4 v[80:83], v12, s[32:35], s12 offen sc1
    buffer_load_dwordx4 v[88:91], v8, s[32:35], s13 offen sc1
    buffer_load_dwordx4 v[92:95], v9, s[32:35], s13 offen sc1
    buffer_load_dwordx4 v[96:99], v10, s[32:35], s13 offen sc1
    buffer_load_dwordx4 v[104:107], v11, s[32:35], s13 offen sc1
    buffer_load_dwordx4 v[108:111], v12, s[32:35], s13 offen sc1
    buffer_load_dwordx4 v[36:39], v8, s[32:35], s14 offen sc1
    buffer_load_dwordx4 v[52:55], v9, s[32:35], s14 offen sc1
    buffer_load_dwordx4 v[68:71], v10, s[32:35], s14 offen sc1
    buffer_load_dwordx4 v[84:87], v11, s[32:35], s14 offen sc1
    buffer_load_dwordx4 v[100:103], v12, s[32:35], s14 offen sc1
    buffer_load_dwordx4 v[112:115], v8, s[32:35], s15 offen sc1
    buffer_load_dwordx4 v[120:123], v9, s[32:35], s15 offen sc1
    buffer_load_dwordx4 v[124:127], v10, s[32:35], s15 offen sc1
    buffer_load_dwordx4 v[116:119], v11, s[32:35], s15 offen sc1
    buffer_load_dwordx4 v[128:131], v12, s[32:35], s15 offen sc1
    buffer_load_dwordx4 v[132:135], v8, s[32:35], s16 offen sc1
    buffer_load_dwordx4 v[136:139], v9, s[32:35], s16 offen sc1
    buffer_load_dwordx4 v[140:143], v10, s[32:35], s16 offen sc1
    buffer_load_dwordx4 v[144:147], v11, s[32:35], s16 offen sc1
    buffer_load_dwordx4 v[148:151], v12, s[32:35], s16 offen sc1
    buffer_load_dwordx4 v[152:155], v8, s[32:35], s17 offen sc1
    buffer_load_dwordx4 v[156:159], v9, s[32:35], s17 offen sc1
    buffer_load_dwordx4 v[160:163], v10, s[32:35], s17 offen sc1
L_sp_tag:
    s_add_u32 s75, s75, 1
    s_cmp_gt_u32 s75, 400000
    s_cbranch_scc1 L_sp_tag_out
    v_mov_b32 v15, 0
    global_load_dword v15, v15, s[46:47] offset:128 sc1
    s_waitcnt vmcnt(0)
    v_readfirstlane_b32 s59, v15
    s_cmp_eq_u32 s59, 0
    s_cbranch_scc1 L_sp_tag
L_sp_tag_out:
    s_lshr_b32 s60, s76, 2
    s_and_b32 s61, s76, 3
    s_lshl4_add_u32 s62, s60, s61
    s_mul_i32 s60, s60, 864
    s_mul_i32 s61, s61, 54
    s_add_u32 s60, s60, s61
    s_mul_i32 s61, s56, 14
    s_add_u32 s60, s60, s61
    s_lshl_b32 s60, s60, 10
    v_lshl_add_u32 v4, v1, 4, s60
    v_add_u32 v5, 221184, v4
    v_add_u32 v6, 442368, v4
    v_add_u32 v7, 663552, v4
    v_and_b32 v2, 3, v1
    v_mul_u32_u24 v2, 26, v2
    v_bfe_u32 v3, v1, 2, 2
    v_mul_u32_u24 v3, 105, v3
    v_bfe_u32 v29, v1, 4, 1
    v_mul_u32_u24 v29, 10, v29
    v_add3_u32 v2, v2, v3, v29
    v_lshrrev_b32 v3, 5, v1
    s_mul_i32 s60, s56, 420
    v_add3_u32 v2, v2, v3, s60
    v_lshlrev_b32 v29, 4, v2
    v_min_u32 v2, 39, v1
    v_mul_u32_u24 v3, 26, v2
    v_lshrrev_b32 v3, 8, v3
    v_lshl_add_u32 v28, v3, 4, v2
    s_mul_i32 s60, s56, 105
    v_add_lshl_u32 v28, v28, s60, 4
    v_mul_u32_u24 v30, 10, v3
    v_sub_u32 v2, v2, v30
    s_lshl_b32 s60, s56, 2
    v_add_u32 v3, s60, v3
    v_add_u32 v26, 53760, v28
    v_add_u32 v27, 53760, v29
    s_lshl_b32 s62, s62, 4
    v_add_u32 v3, s62, v3
    v_mul_u32_u24 v3, 1280, v3
    v_lshl_add_u32 v3, v2, 4, v3
    s_mul_i32 s60, s77, 160
    v_add_u32 v3, s60, v3
    v_cmp_gt_u32 vcc, 40, v1
    v_mov_b32 v2, 2147483648
    s_nop 0
    v_cndmask_b32 v30, v2, v3, vcc
    s_mov_b32 s0, 2147483648
    s_mov_b32 s1, 2147483648
    v_mov_b32 v204, 0
    s_branch L_hslow
L_end:
    s_endpgm
.fill 64, 4, 0xbf800000
.section .rodata,"a"
.p2align 6
.amdhsa_kernel standalone__glu_gated_bilinear__prompt_kernel
  .amdhsa_next_free_vgpr 512
  .amdhsa_next_free_sgpr 102
  .amdhsa_accum_offset 256
  .amdhsa_group_segment_fixed_size 0
  .amdhsa_kernarg_size 56
  .amdhsa_user_sgpr_count 2
  .amdhsa_user_sgpr_kernarg_segment_ptr 1
  .amdhsa_system_sgpr_workgroup_id_x 1
  .amdhsa_float_denorm_mode_32 3
  .amdhsa_float_denorm_mode_16_64 3
.end_amdhsa_kernel
```
